```python
import torch

def _softmax(x, axis=-1):
    return torch.softmax(x, dim=axis)
def _gelu(x):
    return torch.nn.functional.gelu(x, approximate="tanh")
def _silu(x):
    return torch.nn.functional.silu(x)
def _sigmoid(x):
    return torch.sigmoid(x)
def _layernorm(x, axis=-1, eps=1e-5):
    m = x.mean(dim=axis, keepdim=True)
    v = x.var(dim=axis, keepdim=True, unbiased=False)
    return (x - m) / torch.sqrt(v + eps)
def _scatter_add(tgt, idx, src, axis=0):
    return tgt.clone().index_add_(axis, idx, src)
def _segment_sum(src, seg, n):
    out = torch.zeros((n,) + src.shape[1:], dtype=src.dtype)
    return out.index_add_(0, seg, src)
def _pad(x, pw):
    flat = tuple(v for pair in reversed(pw) for v in pair)
    return torch.nn.functional.pad(x, flat)

kernel_name = 'gated_mix__linear_kernel_hedgehog__sliding_block__prompt'

def setup_inputs():

    _w = (lambda a: (lambda t: t.to(torch.bfloat16) if t.is_floating_point() else t)(torch.as_tensor(a)))
    def _A_setup():
        B, S, D, H = 1, 2048, 448, 16
        Dh = D // H
        return {
            "x": _w((lambda *s: torch.randn(*s, dtype=torch.bfloat16) * 0.05)(B, S, D)),
            "wqkv": _w((lambda *s: torch.randn(*s, dtype=torch.bfloat16) * 3.2)(D, 3 * D)),
            "w_phi": _w((lambda *s: torch.randn(*s, dtype=torch.bfloat16) * 3.2)(H, Dh, Dh) * (Dh ** -0.5)),
            "wo": _w((lambda *s: torch.randn(*s, dtype=torch.bfloat16) * 0.1)(D, D)),
        }
    _A_in = _A_setup()

    def _B_setup():
        B, S, D = 1, 2048, 448
        return {
            "x": _w((lambda *s: torch.randn(*s, dtype=torch.bfloat16) * 0.05)(B, S, D)),
            "wqkv": _w((lambda *s: torch.randn(*s, dtype=torch.bfloat16) * 1.6)(D, 3 * D)),
            "wo": _w((lambda *s: torch.randn(*s, dtype=torch.bfloat16) * 0.05)(D, D)),
        }
    _B_in = _B_setup()

    return {
        "A_x": _A_in["x"],
        "A_wqkv": _A_in["wqkv"],
        "A_w_phi": _A_in["w_phi"],
        "A_wo": _A_in["wo"],
        "B_x": _B_in["x"],
        "B_wqkv": _B_in["wqkv"],
        "B_wo": _B_in["wo"],
        "gate_w": _w((lambda *s: torch.randn(*s, dtype=torch.bfloat16) * 0.05)(448) * 16.0),
    }

def reference(A_x, A_wqkv, A_w_phi, A_wo, B_x, B_wqkv, B_wo, gate_w):
    def _A_ref(x, wqkv, w_phi, wo):
        B, S, D = x.shape
        H = 16; Dh = D // H
        qkv = (lambda x, *d: x.permute(*d))((x @ wqkv).reshape(B, S, 3, H, Dh), 2, 0, 3, 1, 4)
        q, k, v = qkv[0], qkv[1], qkv[2]
        pq = torch.einsum("bhsd,hdf->bhsf", q, w_phi)
        pk = torch.einsum("bhsd,hdf->bhsf", k, w_phi)
        phi_q = torch.concatenate([_softmax(pq, axis=-1), _softmax(-pq, axis=-1)], axis=-1)
        phi_k = torch.concatenate([_softmax(pk, axis=-1), _softmax(-pk, axis=-1)], axis=-1)
        kv = torch.einsum("bhsf,bhsd->bhfd", phi_k, v)
        z  = torch.einsum("bhsf->bhf", phi_k)
        num = torch.einsum("bhqf,bhfd->bhqd", phi_q, kv)
        den = torch.einsum("bhqf,bhf->bhq", phi_q, z)[..., None] + 1e-6
        o = num / den
        return (lambda x, *d: x.permute(*d))(o, 0, 2, 1, 3).reshape(B, S, D) @ wo

    def _B_ref(x, wqkv, wo):
        B, S, D = x.shape
        H = 16; Dh = D // H; W = 256
        qkv = (lambda x, *d: x.permute(*d))((x @ wqkv).reshape(B, S, 3, H, Dh), 2, 0, 3, 1, 4)
        q, k, v = qkv[0], qkv[1], qkv[2]
        scores = torch.einsum("bhqd,bhkd->bhqk", q, k) * (Dh ** -0.5)
        idx = torch.arange(S)
        mask = (idx[:, None] - idx[None, :] >= 0) & (idx[:, None] - idx[None, :] < W)
        scores = torch.where(mask[None, None], scores, -1e9)
        p = _softmax(scores, axis=-1)
        o = torch.einsum("bhqk,bhkd->bhqd", p, v)
        return (lambda x, *d: x.permute(*d))(o, 0, 2, 1, 3).reshape(B, S, D) @ wo

    x = A_x
    g = _sigmoid((x * gate_w).sum(-1, keepdims=True))
    a = _A_ref(x, A_wqkv, A_w_phi, A_wo)
    b = _B_ref(x, B_wqkv, B_wo)
    return g * a + (1 - g) * b
```

```asm
; @launch grid=(256,1,1) block=(512,1,1) lds=163840
.amdgcn_target "amdgcn-amd-amdhsa--gfx950"
.text
.p2align 12
L_text:
.globl gated_mix__linear_kernel_hedgehog__sliding_block__prompt_kernel
.p2align 8
.type gated_mix__linear_kernel_hedgehog__sliding_block__prompt_kernel,@function
gated_mix__linear_kernel_hedgehog__sliding_block__prompt_kernel:
    s_load_dwordx16 s[16:31], s[0:1], 0
    s_getpc_b64 s[12:13]
L_pc:
    s_and_b32 s10, s2, 0xf8
    v_add_lshl_u32 v14, s10, v0, 7
    v_cmp_gt_u32 vcc, 8, v0
    v_min_u32 v14, CODE_BYTES, v14
    s_and_saveexec_b64 s[10:11], vcc
    s_cbranch_execz L_nopre
    global_load_dword v255, v14, s[12:13]
L_nopre:
    s_mov_b64 exec, -1
    s_load_dwordx4 s[32:35], s[0:1], 64
    s_load_dwordx2 s[36:37], s[0:1], 80
    s_cmp_ge_u32 s2, 256
    s_cbranch_scc1 L_exit
    v_lshrrev_b32 v13, 6, v0
    v_and_b32 v0, 63, v0
    v_readfirstlane_b32 s3, v13
    s_and_b32 s4, s2, 1
    s_bfe_u32 s10, s2, 0x10001
    s_bfe_u32 s11, s2, 0x10005
    s_bfe_u32 s5, s2, 0x20003
    s_lshr_b32 s12, s2, 6
    s_cmp_eq_u32 s4, 0
    s_cselect_b32 s13, s10, s11
    s_cselect_b32 s10, s11, s10
    s_cselect_b32 s9, s5, s12
    s_cselect_b32 s11, s11, s13
    s_add_u32 s9, s9, s5
    s_add_u32 s9, s9, s12
    s_lshl2_add_u32 s9, s11, s9
    s_and_b32 s11, s10, s4
    s_add_u32 s9, s9, s11
    s_lshl2_add_u32 s5, s13, s5
    s_lshl2_add_u32 s6, s10, s12
    s_and_b32 s10, s2, 4
    s_lshl1_add_u32 s6, s10, s6
    s_mul_i32 s10, s9, 37
    s_lshr_b32 s10, s10, 8
    s_mul_i32 s10, s10, 7
    s_sub_u32 s9, s9, s10
    s_lshl_b32 s76, s9, 7
    s_lshl_b32 s15, s3, 11
    v_lshrrev_b32 v13, 3, v0
    v_and_b32 v14, 7, v0
    v_lshrrev_b32 v15, 4, v0
    v_xor_b32 v15, v15, v14
    s_lshl3_add_u32 s10, s6, s3
    s_lshl_b32 s10, s10, 4
    v_add_u32 v1, s10, v13
    v_mul_u32_u24 v1, 896, v1
    v_lshl_add_u32 v1, v15, 4, v1
    s_mov_b32 s42, 1835008
    s_mov_b32 s43, 0x20000
    s_mov_b32 m0, s15
    s_waitcnt lgkmcnt(0)
    s_mov_b32 s40, s16
    s_mov_b32 s41, s17
    buffer_load_dwordx4 v1, s[40:43], s76 offen lds
    v_xor_b32 v2, 64, v1
    v_add_u32 v2, 7168, v2
    s_add_u32 m0, s15, 1024
    s_nop 0
    buffer_load_dwordx4 v2, s[40:43], s76 offen lds
    s_mul_i32 s83, s9, 172032
    s_lshl_b32 s14, s3, 10
    v_lshlrev_b32 v15, 1, v13
    v_and_b32 v15, 4, v15
    v_xor_b32 v15, v15, v14
    v_and_b32 v14, 1, v13
    v_xor_b32 v15, v15, v14
    s_and_b32 s10, s3, 1
    s_lshl_b32 s10, s10, 1
    v_xor_b32 v15, s10, v15
    s_lshl_b32 s10, s3, 3
    v_add_u32 v13, s10, v13
    v_mul_u32_u24 v13, 2688, v13
    s_add_u32 s10, s4, 6
    v_min_u32 v14, s10, v15
    v_lshl_add_u32 v3, v14, 4, v13
    s_lshl4_add_u32 s10, s4, 112
    s_mul_i32 s10, s10, s5
    s_add_u32 s10, s10, 896
    s_mov_b32 s99, s14
    v_add_u32 v3, s10, v3
    s_lshl3_add_u32 s93, s4, s5
    s_cmp_eq_u32 s93, 15
    s_cselect_b32 s74, 0, 1204224
    s_cmp_eq_u32 s4, 0
    s_cselect_b32 s72, s18, s26
    s_cselect_b32 s73, s19, s27
    s_mov_b32 s75, 0x20000
    s_add_u32 m0, s99, 49152
    s_nop 0
    buffer_load_dwordx4 v3, s[72:75], s83 offen lds
    v_lshlrev_b32 v12, 4, v0
    s_mov_b32 s55, 0x20000
    s_mul_i32 s10, s5, 3136
    s_add_u32 s11, s10, 3136
    s_add_u32 s10, s10, s14
    s_cmp_eq_u32 s3, 4
    s_cselect_b32 s52, s30, s20
    s_cselect_b32 s53, s31, s21
    s_cselect_b32 s54, 896, s11
    s_cselect_b32 s10, 0, s10
    s_add_u32 m0, s14, 98304
    s_lshl3_add_u32 s11, s4, s3
    s_bitcmp1_b32 0x101f, s11
    s_cbranch_scc0 L_nosmall
    buffer_load_dwordx4 v12, s[52:55], s10 offen lds
L_nosmall:
    s_mov_b32 s44, s72
    s_mov_b32 s45, s73
    s_mov_b32 s46, 1204224
    s_mov_b32 s47, 0x20000
    v_min_u32 v14, 6, v15
    v_lshl_add_u32 v5, v14, 4, v13
    s_mul_i32 s10, s5, 112
    v_add_u32 v5, s10, v5
    s_add_u32 s77, s76, 128
    s_cmp_eq_u32 s77, 896
    s_cselect_b32 s77, 0, s77
    s_mul_i32 s84, s77, 1344
    s_add_u32 s78, s77, 128
    s_cmp_eq_u32 s78, 896
    s_cselect_b32 s78, 0, s78
    s_mul_i32 s85, s78, 1344
    s_add_u32 s79, s78, 128
    s_cmp_eq_u32 s79, 896
    s_cselect_b32 s79, 0, s79
    s_mul_i32 s86, s79, 1344
    s_add_u32 s80, s79, 128
    s_cmp_eq_u32 s80, 896
    s_cselect_b32 s80, 0, s80
    s_mul_i32 s87, s80, 1344
    s_add_u32 s81, s80, 128
    s_cmp_eq_u32 s81, 896
    s_cselect_b32 s81, 0, s81
    s_mul_i32 s88, s81, 1344
    s_add_u32 s82, s81, 128
    s_cmp_eq_u32 s82, 896
    s_cselect_b32 s82, 0, s82
    s_mul_i32 s89, s82, 1344
    v_cmp_ne_u32 s[90:91], 7, v15
    s_and_b32 s7, s3, 3
    s_lshr_b32 s8, s3, 2
    s_barrier
    s_add_u32 m0, s15, 16384
    s_nop 0
    buffer_load_dwordx4 v1, s[40:43], s77 offen lds
    s_mov_b32 s48, s36
    s_mov_b32 s49, s37
    s_mov_b32 s50, 10485760
    s_mov_b32 s51, 0x20000
    s_mov_b32 s56, s32
    s_mov_b32 s57, s33
    s_mov_b32 s58, 1835008
    s_mov_b32 s59, 0x20000
    s_mov_b32 s68, s34
    s_mov_b32 s69, s35
    s_mov_b32 s70, 256
    s_mov_b32 s71, 0x20000
    s_mov_b32 s60, s22
    s_mov_b32 s61, s23
    s_mov_b32 s62, 401408
    s_mov_b32 s63, 0x20000
    s_mov_b32 s64, s28
    s_mov_b32 s65, s29
    s_mov_b32 s66, 401408
    s_mov_b32 s67, 0x20000
    s_lshl4_add_u32 s93, s93, s6
    s_lshl_b32 s38, s93, 7
    s_lshr_b32 s10, s2, 3
    s_min_u32 s10, s10, 27
    s_mul_i32 s11, s10, 37
    s_lshr_b32 s11, s11, 8
    s_mul_i32 s12, s11, 7
    s_sub_u32 s96, s10, s12
    s_and_b32 s95, s2, 7
    s_lshl2_add_u32 s95, s95, s11
    s_mov_b32 s92, 0x3f803f80
    s_mov_b32 s97, 0xff800000
    v_and_b32 v13, 31, v0
    v_lshrrev_b32 v14, 5, v0
    v_bfe_u32 v15, v0, 1, 3
    v_xor_b32 v15, v15, v14
    v_lshlrev_b32 v15, 4, v15
    v_lshl_add_u32 v15, v13, 7, v15
    s_lshl_b32 s10, s7, 12
    v_add_u32 v6, s10, v15
    v_xor_b32 v7, 32, v6
    v_xor_b32 v8, 64, v6
    v_xor_b32 v9, 96, v6
    v_add_u32 v11, -1, v14
    v_and_b32 v198, 15, v0
    v_lshlrev_b32 v198, 2, v198
    v_mov_b32 v249, 0
    v_mov_b32 v251, 0
    v_and_b32 v193, 0x33, v0
    v_bfe_u32 v13, v0, 2, 1
    v_lshl_or_b32 v193, v13, 3, v193
    v_bfe_u32 v14, v0, 3, 1
    v_lshl_or_b32 v193, v14, 2, v193
    v_lshlrev_b32 v13, 1, v13
    v_and_b32 v14, 1, v0
    v_or_b32 v13, v13, v14
    v_bfe_u32 v14, v0, 1, 1
    v_lshl_or_b32 v13, v14, 2, v13
    v_xor_b32 v13, 7, v13
    v_lshlrev_b32 v13, 4, v13
    v_lshl_add_u32 v13, v193, 7, v13
    s_min_u32 s11, s3, 6
    s_lshl_b32 s10, s11, 13
    s_add_u32 s10, s10, 106496
    v_add_u32 v199, s10, v13
    v_lshlrev_b32 v193, 1, v193
    s_add_u32 s10, s9, s11
    s_cmp_ge_u32 s10, 7
    s_cselect_b32 s11, 7, 0
    s_sub_u32 s10, s10, s11
    s_lshl_b32 s10, s10, 7
    s_add_u32 s10, s10, 102400
    v_add_u32 v193, s10, v193
    s_cmp_eq_u32 s4, 0
    s_cbranch_scc0 L_path_b
L_path_a:
    v_add_u32 v4, 1792, v5
    v_and_b32 v13, 3, v0
    v_bfe_u32 v15, v0, 4, 1
    v_lshl_add_u32 v13, v15, 2, v13
    v_add_u32 v15, 1, v13
    v_lshrrev_b32 v15, 3, v15
    s_mul_i32 s10, s8, 56
    v_lshl_add_u32 v13, v13, 3, s10
    s_xor_b32 s10, s8, 1
    s_lshl_b32 s10, s10, 6
    v_mul_u32_u24 v15, s10, v15
    v_add_u32 v13, v15, v13
    v_bfe_u32 v15, v0, 3, 1
    v_lshlrev_b32 v15, 6, v15
    v_xor_b32 v13, v15, v13
    v_bfe_u32 v15, v0, 2, 1
    v_lshlrev_b32 v15, 4, v15
    v_xor_b32 v13, v15, v13
    v_and_b32 v15, 32, v0
    v_xor_b32 v13, v15, v13
    v_lshl_add_u32 v13, v15, 5, v13
    v_bfe_u32 v15, v0, 2, 2
    v_lshl_add_u32 v13, v15, 7, v13
    v_add_u32 v10, 49152, v13
    v_and_b32 v13, 3, v0
    v_bfe_u32 v14, v0, 4, 1
    v_lshl_add_u32 v13, v14, 2, v13
    v_bfe_u32 v14, v0, 2, 2
    v_lshrrev_b32 v15, 5, v0
    v_lshl_add_u32 v14, v15, 2, v14
    v_mul_u32_u24 v155, 56, v14
    v_lshl_add_u32 v155, v13, 3, v155
    s_mul_i32 s10, s8, 1568
    s_add_u32 s10, s10, 98304
    v_add_u32 v155, s10, v155
    s_and_b32 s10, s3, 1
    s_lshl_b32 s10, s10, 3
    v_add_u32 v13, s10, v13
    v_and_b32 v15, 5, v14
    v_xor_b32 v13, v15, v13
    v_and_b32 v15, 8, v0
    v_xor_b32 v13, v15, v13
    v_lshlrev_b32 v13, 3, v13
    v_lshl_add_u32 v13, v14, 7, v13
    s_bfe_u32 s10, s3, 0x10001
    s_lshl_b32 s11, s10, 14
    v_add_u32 v145, s11, v13
    v_xor_b32 v146, 16, v145
    s_lshl_b32 s11, s10, 13
    v_add_u32 v147, s11, v12
    s_lshl_b32 s11, s5, 1
    s_add_u32 s10, s10, s11
    s_lshl_b32 s10, s10, 4
    s_add_u32 s10, s10, s6
    s_lshl_b32 s10, s10, 1
    s_and_b32 s11, s3, 1
    s_add_u32 s10, s10, s11
    s_mul_i32 s10, s10, 2048
    s_add_u32 s39, s10, 5242880
    s_lshl_b32 s10, s5, 1
    s_add_u32 s10, s10, s8
    s_lshl_b32 s10, s10, 5
    s_lshr_b32 s11, s7, 1
    s_add_u32 s10, s10, s11
    s_mul_i32 s10, s10, 2048
    s_and_b32 s11, s7, 1
    s_lshl_b32 s11, s11, 10
    s_add_u32 s10, s10, s11
    s_add_u32 s1, s10, 5242880
    v_and_b32 v13, 5, v0
    v_bfe_u32 v14, v0, 1, 1
    v_lshl_or_b32 v13, v14, 3, v13
    v_bfe_u32 v14, v0, 3, 1
    v_lshl_or_b32 v13, v14, 1, v13
    v_lshrrev_b32 v14, 5, v0
    v_xor_b32 v13, v14, v13
    v_lshlrev_b32 v13, 3, v13
    v_and_b32 v14, 31, v0
    v_lshl_add_u32 v13, v14, 7, v13
    s_lshl_b32 s10, s3, 12
    v_add_u32 v144, s10, v13
    v_add_u32 v154, s15, v12
    v_add_u32 v152, s14, v12
    s_lshl_b32 s10, s8, 12
    v_add_u32 v153, s10, v12
    v_and_b32 v13, 15, v0
    v_lshlrev_b32 v13, 7, v13
    s_lshl_b32 s10, s5, 11
    v_mov_b32 v194, s38
    v_mov_b32 v157, 0x3fb8aa3b
    v_and_b32 v156, 1.0, v11
    v_and_b32 v13, 31, v0
    v_lshrrev_b32 v14, 5, v0
    v_lshlrev_b32 v14, 2, v14
    v_sub_u32 v13, v13, v14
    v_mov_b32 v14, 0x3f80
    v_mov_b32 v15, 0x3f800000
    v_cmp_eq_u32 vcc, 0, v13
    s_nop 1
    v_cndmask_b32 v148, 0, v14, vcc
    v_cmp_eq_u32 vcc, 1, v13
    s_nop 1
    v_cndmask_b32 v148, v148, v15, vcc
    v_cmp_eq_u32 vcc, 2, v13
    s_nop 1
    v_cndmask_b32 v149, 0, v14, vcc
    v_cmp_eq_u32 vcc, 3, v13
    s_nop 1
    v_cndmask_b32 v149, v149, v15, vcc
    v_cmp_eq_u32 vcc, 8, v13
    s_nop 1
    v_cndmask_b32 v150, 0, v14, vcc
    v_cmp_eq_u32 vcc, 9, v13
    s_nop 1
    v_cndmask_b32 v150, v150, v15, vcc
    v_cmp_eq_u32 vcc, 10, v13
    s_nop 1
    v_cndmask_b32 v151, 0, v14, vcc
    v_cmp_eq_u32 vcc, 11, v13
    s_nop 1
    v_cndmask_b32 v151, v151, v15, vcc
    s_add_u32 m0, s15, 17408
    s_nop 0
    buffer_load_dwordx4 v2, s[40:43], s77 offen lds
    s_add_u32 m0, s99, 65536
    s_nop 0
    buffer_load_dwordx4 v3, s[72:75], s84 offen lds
    s_waitcnt vmcnt(3)
    s_barrier
    ds_read_b128 v[16:19], v6 offset:0
    ds_read_b64_tr_b16 v[128:129], v10 offset:0
    ds_read_b64_tr_b16 v[130:131], v10 offset:512
    ds_read_b128 v[20:23], v7 offset:0
    ds_read_b64_tr_b16 v[132:133], v10 offset:2048
    ds_read_b64_tr_b16 v[134:135], v10 offset:2560
    ds_read_b128 v[24:27], v8 offset:0
    ds_read_b64_tr_b16 v[136:137], v10 offset:4096
    ds_read_b64_tr_b16 v[138:139], v10 offset:4608
    ds_read_b128 v[28:31], v9 offset:0
    ds_read_b64_tr_b16 v[140:141], v10 offset:6144
    ds_read_b64_tr_b16 v[142:143], v10 offset:6656
    ds_read_u16 v248, v193
    ds_read_b64_tr_b16 v[240:241], v155 offset:0
    ds_read_b64_tr_b16 v[242:243], v155 offset:448
    ds_read_b64_tr_b16 v[244:245], v155 offset:896
    ds_read_b64_tr_b16 v[246:247], v155 offset:1344
    s_add_u32 m0, s15, 32768
    s_nop 0
    buffer_load_dwordx4 v1, s[40:43], s78 offen lds
    s_waitcnt lgkmcnt(14)
    v_mfma_f32_32x32x16_bf16 v[160:175], v[128:131], v[16:19], 0
    s_add_u32 m0, s15, 33792
    s_nop 0
    buffer_load_dwordx4 v2, s[40:43], s78 offen lds
    s_waitcnt lgkmcnt(11)
    v_mfma_f32_32x32x16_bf16 v[160:175], v[132:135], v[20:23], v[160:175]
    s_add_u32 m0, s99, 81920
    s_nop 0
    buffer_load_dwordx4 v3, s[72:75], s85 offen lds
    s_waitcnt lgkmcnt(5)
    s_waitcnt vmcnt(3)
    s_barrier
    v_mfma_f32_32x32x16_bf16 v[160:175], v[136:139], v[24:27], v[160:175]
    ds_read_b128 v[32:35], v6 offset:16384
    ds_read_b64_tr_b16 v[128:129], v10 offset:16384
    ds_read_b64_tr_b16 v[130:131], v10 offset:16896
    ds_read_b128 v[36:39], v7 offset:16384
    ds_read_b64_tr_b16 v[132:133], v10 offset:18432
    ds_read_b64_tr_b16 v[134:135], v10 offset:18944
    v_mfma_f32_32x32x16_bf16 v[160:175], v[140:143], v[28:31], v[160:175]
    ds_read_b128 v[40:43], v8 offset:16384
    ds_read_b64_tr_b16 v[136:137], v10 offset:20480
    ds_read_b64_tr_b16 v[138:139], v10 offset:20992
    ds_read_b128 v[44:47], v9 offset:16384
    ds_read_b64_tr_b16 v[140:141], v10 offset:22528
    ds_read_b64_tr_b16 v[142:143], v10 offset:23040
    s_add_u32 m0, s15, 0
    s_nop 0
    buffer_load_dwordx4 v1, s[40:43], s79 offen lds
    s_waitcnt lgkmcnt(9)
    v_mfma_f32_32x32x16_bf16 v[160:175], v[128:131], v[32:35], v[160:175]
    s_add_u32 m0, s15, 1024
    s_nop 0
    buffer_load_dwordx4 v2, s[40:43], s79 offen lds
    v_and_b32 v13, 31, v0
    v_subrev_u32 v13, 28, v13
    v_ashrrev_i32 v13, 31, v13
    v_and_b32 v240, v13, v240
    v_and_b32 v241, v13, v241
    v_and_b32 v242, v13, v242
    v_and_b32 v243, v13, v243
    v_and_b32 v244, v13, v244
    v_and_b32 v245, v13, v245
    v_and_b32 v246, v13, v246
    v_and_b32 v247, v13, v247
    v_mov_b32 v250, v248
    s_waitcnt lgkmcnt(6)
    v_mfma_f32_32x32x16_bf16 v[160:175], v[132:135], v[36:39], v[160:175]
    ds_write_b128 v199, v[248:251]
    s_add_u32 m0, s99, 49152
    s_nop 0
    buffer_load_dwordx4 v3, s[72:75], s86 offen lds
    s_waitcnt lgkmcnt(1)
    s_waitcnt vmcnt(3)
    s_barrier
    v_mfma_f32_32x32x16_bf16 v[160:175], v[136:139], v[40:43], v[160:175]
    ds_read_b128 v[48:51], v6 offset:32768
    ds_read_b64_tr_b16 v[128:129], v10 offset:32768
    ds_read_b64_tr_b16 v[130:131], v10 offset:33280
    ds_read_b128 v[52:55], v7 offset:32768
    ds_read_b64_tr_b16 v[132:133], v10 offset:34816
    ds_read_b64_tr_b16 v[134:135], v10 offset:35328
    v_bfe_u32 v13, v0, 2, 2
    v_and_b32 v14, 3, v0
    v_lshlrev_b32 v14, 3, v14
    v_lshl_add_u32 v14, v13, 7, v14
    v_mfma_f32_32x32x16_bf16 v[160:175], v[140:143], v[44:47], v[160:175]
    ds_read_b128 v[56:59], v8 offset:32768
    ds_read_b64_tr_b16 v[136:137], v10 offset:36864
    ds_read_b64_tr_b16 v[138:139], v10 offset:37376
    ds_read_b128 v[60:63], v9 offset:32768
    ds_read_b64_tr_b16 v[140:141], v10 offset:38912
    ds_read_b64_tr_b16 v[142:143], v10 offset:39424
    s_add_u32 m0, s15, 16384
    s_nop 0
    buffer_load_dwordx4 v1, s[40:43], s80 offen lds
    s_mul_i32 s10, s8, 28672
    v_add_u32 v252, s10, v14
    v_lshrrev_b32 v13, 1, v13
    s_lshl_b32 s10, s8, 1
    v_xor_b32 v13, s10, v13
    s_waitcnt lgkmcnt(9)
    v_mfma_f32_32x32x16_bf16 v[160:175], v[128:131], v[48:51], v[160:175]
    s_add_u32 m0, s15, 17408
    s_nop 0
    buffer_load_dwordx4 v2, s[40:43], s80 offen lds
    v_bfe_u32 v14, v0, 4, 1
    v_lshlrev_b32 v14, 1, v14
    v_xor_b32 v13, v14, v13
    s_waitcnt lgkmcnt(6)
    v_mfma_f32_32x32x16_bf16 v[160:175], v[132:135], v[52:55], v[160:175]
    s_add_u32 m0, s99, 65536
    s_nop 0
    buffer_load_dwordx4 v3, s[72:75], s87 offen lds
    s_waitcnt lgkmcnt(0)
    s_waitcnt vmcnt(3)
    s_barrier
    v_mfma_f32_32x32x16_bf16 v[160:175], v[136:139], v[56:59], v[160:175]
    ds_read_b128 v[64:67], v6 offset:0
    ds_read_b64_tr_b16 v[128:129], v10 offset:0
    ds_read_b64_tr_b16 v[130:131], v10 offset:512
    ds_read_b128 v[68:71], v7 offset:0
    ds_read_b64_tr_b16 v[132:133], v10 offset:2048
    ds_read_b64_tr_b16 v[134:135], v10 offset:2560
    v_lshlrev_b32 v253, 5, v13
    v_and_b32 v13, 15, v0
    s_and_b32 s10, s7, 1
    s_lshl_b32 s10, s10, 4
    v_add_u32 v158, s10, v13
    v_mfma_f32_32x32x16_bf16 v[160:175], v[140:143], v[60:63], v[160:175]
    ds_read_b128 v[72:75], v8 offset:0
    ds_read_b64_tr_b16 v[136:137], v10 offset:4096
    ds_read_b64_tr_b16 v[138:139], v10 offset:4608
    ds_read_b128 v[76:79], v9 offset:0
    ds_read_b64_tr_b16 v[140:141], v10 offset:6144
    ds_read_b64_tr_b16 v[142:143], v10 offset:6656
    s_add_u32 m0, s15, 32768
    s_nop 0
    buffer_load_dwordx4 v1, s[40:43], s81 offen lds
    s_mul_i32 s10, s95, 7
    s_add_u32 s10, s10, s96
    s_lshl_b32 s10, s10, 7
    s_add_u32 s10, s10, 32768
    v_mov_b32 v195, s10
    s_waitcnt lgkmcnt(9)
    v_mfma_f32_32x32x16_bf16 v[160:175], v[128:131], v[64:67], v[160:175]
    s_add_u32 m0, s15, 33792
    s_nop 0
    buffer_load_dwordx4 v2, s[40:43], s81 offen lds
    v_and_b32 v192, 15, v0
    s_lshl_b32 s10, s95, 6
    s_lshl_b32 s11, s7, 4
    s_add_u32 s10, s10, s11
    v_add_u32 v192, s10, v192
    s_waitcnt lgkmcnt(6)
    v_mfma_f32_32x32x16_bf16 v[160:175], v[132:135], v[68:71], v[160:175]
    s_add_u32 m0, s99, 81920
    s_nop 0
    buffer_load_dwordx4 v3, s[72:75], s88 offen lds
    s_waitcnt lgkmcnt(0)
    s_branch L_pg_a_1_go
.p2align 12
L_pg_a_1_go:
    s_waitcnt vmcnt(3)
    s_barrier
    v_mfma_f32_32x32x16_bf16 v[160:175], v[136:139], v[72:75], v[160:175]
    ds_read_b128 v[80:83], v6 offset:16384
    ds_read_b64_tr_b16 v[128:129], v10 offset:16384
    ds_read_b64_tr_b16 v[130:131], v10 offset:16896
    ds_read_b128 v[84:87], v7 offset:16384
    ds_read_b64_tr_b16 v[132:133], v10 offset:18432
    ds_read_b64_tr_b16 v[134:135], v10 offset:18944
    v_mul_u32_u24 v192, 896, v192
    v_bfe_u32 v13, v0, 4, 1
    v_lshl_add_u32 v192, v13, 5, v192
    v_mfma_f32_32x32x16_bf16 v[160:175], v[140:143], v[76:79], v[160:175]
    ds_read_b128 v[88:91], v8 offset:16384
    ds_read_b64_tr_b16 v[136:137], v10 offset:20480
    ds_read_b64_tr_b16 v[138:139], v10 offset:20992
    ds_read_b128 v[92:95], v9 offset:16384
    ds_read_b64_tr_b16 v[140:141], v10 offset:22528
    ds_read_b64_tr_b16 v[142:143], v10 offset:23040
    s_add_u32 m0, s15, 0
    s_nop 0
    buffer_load_dwordx4 v1, s[40:43], s82 offen lds
    v_lshrrev_b32 v13, 5, v0
    v_lshl_add_u32 v192, v13, 4, v192
    s_lshl_b32 s10, s96, 7
    s_lshl_b32 s11, s8, 6
    s_add_u32 s10, s10, s11
    v_add_u32 v192, s10, v192
    s_waitcnt lgkmcnt(9)
    v_mfma_f32_32x32x16_bf16 v[160:175], v[128:131], v[80:83], v[160:175]
    s_add_u32 m0, s15, 1024
    s_nop 0
    buffer_load_dwordx4 v2, s[40:43], s82 offen lds
    s_waitcnt lgkmcnt(6)
    v_mfma_f32_32x32x16_bf16 v[160:175], v[132:135], v[84:87], v[160:175]
    s_add_u32 m0, s99, 49152
    s_nop 0
    buffer_load_dwordx4 v3, s[72:75], s89 offen lds
    s_waitcnt lgkmcnt(0)
    s_waitcnt vmcnt(3)
    s_barrier
    v_mfma_f32_32x32x16_bf16 v[160:175], v[136:139], v[88:91], v[160:175]
    ds_read_b128 v[96:99], v6 offset:32768
    ds_read_b64_tr_b16 v[128:129], v10 offset:32768
    ds_read_b64_tr_b16 v[130:131], v10 offset:33280
    ds_read_b128 v[100:103], v7 offset:32768
    ds_read_b64_tr_b16 v[132:133], v10 offset:34816
    ds_read_b64_tr_b16 v[134:135], v10 offset:35328
    v_lshrrev_b32 v13, 3, v0
    v_and_b32 v14, 7, v0
    v_bfe_u32 v15, v0, 4, 2
    v_lshlrev_b32 v15, 1, v15
    v_xor_b32 v14, v15, v14
    s_lshl_b32 s10, s3, 3
    v_add_u32 v1, s10, v13
    v_mul_u32_u24 v1, 896, v1
    v_lshl_add_u32 v1, v14, 4, v1
    s_lshl_b32 s10, s96, 7
    v_add_u32 v1, s10, v1
    s_add_u32 s98, s14, 106496
    s_add_u32 s99, s14, 49152
    s_and_b32 s76, s95, 3
    s_lshl_b32 s76, s76, 14
    s_add_u32 s77, s76, 8192
    s_cmp_eq_u32 s77, 57344
    s_cselect_b32 s77, 0, s77
    v_mfma_f32_32x32x16_bf16 v[160:175], v[140:143], v[92:95], v[160:175]
    ds_read_b128 v[104:107], v8 offset:32768
    ds_read_b64_tr_b16 v[136:137], v10 offset:36864
    ds_read_b64_tr_b16 v[138:139], v10 offset:37376
    ds_read_b128 v[108:111], v9 offset:32768
    ds_read_b64_tr_b16 v[140:141], v10 offset:38912
    ds_read_b64_tr_b16 v[142:143], v10 offset:39424
    s_add_u32 s78, s77, 8192
    s_cmp_eq_u32 s78, 57344
    s_cselect_b32 s78, 0, s78
    s_add_u32 s79, s78, 8192
    s_cmp_eq_u32 s79, 57344
    s_cselect_b32 s79, 0, s79
    s_add_u32 s80, s79, 8192
    s_cmp_eq_u32 s80, 57344
    s_cselect_b32 s80, 0, s80
    s_add_u32 s81, s80, 8192
    s_cmp_eq_u32 s81, 57344
    s_cselect_b32 s81, 0, s81
    s_add_u32 s82, s81, 8192
    s_cmp_eq_u32 s82, 57344
    s_cselect_b32 s82, 0, s82
    s_lshl2_add_u32 s10, s6, s7
    s_lshl_b32 s10, s10, 5
    s_lshr_b32 s11, s93, 4
    s_lshl1_add_u32 s11, s11, s8
    s_add_u32 s10, s10, s11
    s_mul_i32 s10, s10, 2048
    s_add_u32 s93, s10, 6291456
    s_waitcnt lgkmcnt(9)
    v_mfma_f32_32x32x16_bf16 v[160:175], v[128:131], v[96:99], v[160:175]
    s_add_u32 m0, s14, 106496
    s_mov_b64 exec, s[90:91]
    buffer_load_dwordx4 v4, s[44:47], s83 offen lds
    s_mov_b64 exec, -1
    v_mov_b32 v255, 1
    v_lshlrev_b32 v193, 7, v0
    s_mov_b32 s40, s48
    s_mov_b32 s41, s49
    s_cmp_eq_u32 s3, 0
    s_cselect_b32 s42, 81920, 0
    v_mov_b32 v248, s92
    v_mov_b32 v249, s92
    v_mov_b32 v250, s92
    v_mov_b32 v251, s92
    s_waitcnt lgkmcnt(6)
    v_mfma_f32_32x32x16_bf16 v[160:175], v[132:135], v[100:103], v[160:175]
    s_add_u32 m0, s14, 114688
    s_mov_b64 exec, s[90:91]
    buffer_load_dwordx4 v4, s[44:47], s84 offen lds
    s_mov_b64 exec, -1
    s_waitcnt lgkmcnt(0)
    s_waitcnt vmcnt(2)
    s_barrier
    v_mfma_f32_32x32x16_bf16 v[160:175], v[136:139], v[104:107], v[160:175]
    ds_read_b128 v[112:115], v6 offset:0
    ds_read_b64_tr_b16 v[128:129], v10 offset:0
    ds_read_b64_tr_b16 v[130:131], v10 offset:512
    ds_read_b128 v[116:119], v7 offset:0
    ds_read_b64_tr_b16 v[132:133], v10 offset:2048
    ds_read_b64_tr_b16 v[134:135], v10 offset:2560
    v_mfma_f32_32x32x16_bf16 v[160:175], v[140:143], v[108:111], v[160:175]
    ds_read_b128 v[120:123], v8 offset:0
    ds_read_b64_tr_b16 v[136:137], v10 offset:4096
    ds_read_b64_tr_b16 v[138:139], v10 offset:4608
    ds_read_b128 v[124:127], v9 offset:0
    ds_read_b64_tr_b16 v[140:141], v10 offset:6144
    ds_read_b64_tr_b16 v[142:143], v10 offset:6656
    v_add_u32 v10, 57344, v10
    v_xor_b32 v2, 16, v144
    v_xor_b32 v3, 32, v144
    v_xor_b32 v6, 48, v144
    v_xor_b32 v7, 64, v144
    s_waitcnt lgkmcnt(9)
    v_mfma_f32_32x32x16_bf16 v[160:175], v[128:131], v[112:115], v[160:175]
    s_mov_b32 exec_lo, 0x10000000
    s_mov_b32 exec_hi, 0x10000000
    ds_write_b128 v154, v[248:251] offset:32768
    ds_write_b128 v154, v[248:251] offset:33792
    s_mov_b64 exec, -1
    s_add_u32 m0, s14, 122880
    s_mov_b64 exec, s[90:91]
    buffer_load_dwordx4 v4, s[44:47], s85 offen lds
    s_mov_b64 exec, -1
    v_xor_b32 v8, 80, v144
    v_xor_b32 v9, 96, v144
    v_xor_b32 v159, 112, v144
    s_waitcnt lgkmcnt(8)
    v_mfma_f32_32x32x16_bf16 v[160:175], v[132:135], v[116:119], v[160:175]
    s_waitcnt lgkmcnt(2)
    s_waitcnt vmcnt(2)
    s_barrier
    v_mfma_f32_32x32x16_bf16 v[160:175], v[136:139], v[120:123], v[160:175]
    ds_read_b64_tr_b16 v[128:129], v10 offset:0
    ds_read_b64_tr_b16 v[130:131], v10 offset:512
    ds_read_b64_tr_b16 v[132:133], v10 offset:2048
    ds_read_b64_tr_b16 v[134:135], v10 offset:2560
    v_mfma_f32_32x32x16_bf16 v[160:175], v[140:143], v[124:127], v[160:175]
    ds_read_b64_tr_b16 v[136:137], v10 offset:4096
    ds_read_b64_tr_b16 v[138:139], v10 offset:4608
    ds_read_b64_tr_b16 v[140:141], v10 offset:6144
    ds_read_b64_tr_b16 v[142:143], v10 offset:6656
    s_waitcnt lgkmcnt(6)
    v_mfma_f32_32x32x16_bf16 v[176:191], v[16:19], v[128:131], 0
    s_add_u32 m0, s14, 131072
    s_mov_b64 exec, s[90:91]
    buffer_load_dwordx4 v4, s[44:47], s86 offen lds
    s_mov_b64 exec, -1
    s_nop 1
    v_mul_f32 v160, v157, v160
    v_mul_f32 v161, v157, v161
    v_mul_f32 v162, v157, v162
    v_mul_f32 v163, v157, v163
    v_cvt_pk_bf16_f32 v200, v160, v161
    v_mul_f32 v164, v157, v164
    v_mul_f32 v165, v157, v165
    v_cvt_pk_bf16_f32 v201, v162, v163
    v_mul_f32 v166, v157, v166
    v_mul_f32 v167, v157, v167
    v_cvt_pk_bf16_f32 v202, v164, v165
    v_mul_f32 v168, v157, v168
    v_mul_f32 v169, v157, v169
    v_cvt_pk_bf16_f32 v203, v166, v167
    v_mul_f32 v170, v157, v170
    s_waitcnt lgkmcnt(4)
    v_mfma_f32_32x32x16_bf16 v[176:191], v[20:23], v[132:135], v[176:191]
    v_mul_f32 v171, v157, v171
    v_cvt_pk_bf16_f32 v204, v168, v169
    v_mul_f32 v172, v157, v172
    v_mul_f32 v173, v157, v173
    v_cvt_pk_bf16_f32 v205, v170, v171
    v_mul_f32 v174, v157, v174
    v_mul_f32 v175, v157, v175
    v_cvt_pk_bf16_f32 v206, v172, v173
    v_cvt_pk_bf16_f32 v207, v174, v175
    v_and_b32 v206, v11, v206
    v_and_b32 v207, v11, v207
    v_mfma_f32_32x32x16_bf16 v[208:223], v[240:243], v[200:203], 0
    s_nop 0
    v_mfma_f32_32x32x16_bf16 v[208:223], v[244:247], v[204:207], v[208:223]
    s_waitcnt lgkmcnt(0)
    s_waitcnt vmcnt(2)
    s_barrier
    s_setprio 3
    v_mfma_f32_32x32x16_bf16 v[176:191], v[24:27], v[136:139], v[176:191]
    ds_read_b64_tr_b16 v[128:129], v10 offset:8192
    ds_read_b64_tr_b16 v[130:131], v10 offset:8704
    ds_read_b64_tr_b16 v[132:133], v10 offset:10240
    ds_read_b64_tr_b16 v[134:135], v10 offset:10752
    s_nop 2
    v_exp_f32 v224, v208
    v_exp_f32_e64 v208, -v208
    v_exp_f32 v225, v209
    v_exp_f32_e64 v209, -v209
    v_exp_f32 v226, v210
    s_setprio 2
    v_mfma_f32_32x32x16_bf16 v[176:191], v[28:31], v[140:143], v[176:191]
    ds_read_b64_tr_b16 v[136:137], v10 offset:12288
    ds_read_b64_tr_b16 v[138:139], v10 offset:12800
    ds_read_b64_tr_b16 v[140:141], v10 offset:14336
    ds_read_b64_tr_b16 v[142:143], v10 offset:14848
    v_exp_f32_e64 v210, -v210
    v_add_f32 v248, v224, v225
    v_add_f32 v250, v208, v209
    v_exp_f32 v227, v211
    v_exp_f32_e64 v211, -v211
    v_add_f32 v248, v248, v226
    s_setprio 1
    s_waitcnt lgkmcnt(6)
    v_mfma_f32_32x32x16_bf16 v[176:191], v[32:35], v[128:131], v[176:191]
    s_add_u32 m0, s14, 139264
    s_mov_b64 exec, s[90:91]
    buffer_load_dwordx4 v4, s[44:47], s87 offen lds
    s_mov_b64 exec, -1
    v_add_f32 v250, v250, v210
    v_exp_f32 v228, v212
    v_exp_f32_e64 v212, -v212
    v_add_f32 v248, v248, v227
    v_add_f32 v250, v250, v211
    v_exp_f32 v229, v213
    s_setprio 0
    s_waitcnt lgkmcnt(4)
    v_mfma_f32_32x32x16_bf16 v[176:191], v[36:39], v[132:135], v[176:191]
    s_waitcnt lgkmcnt(0)
    s_waitcnt vmcnt(2)
    s_barrier
    s_setprio 3
    v_mfma_f32_32x32x16_bf16 v[176:191], v[40:43], v[136:139], v[176:191]
    ds_read_b64_tr_b16 v[128:129], v10 offset:16384
    ds_read_b64_tr_b16 v[130:131], v10 offset:16896
    ds_read_b64_tr_b16 v[132:133], v10 offset:18432
    ds_read_b64_tr_b16 v[134:135], v10 offset:18944
    v_exp_f32_e64 v213, -v213
    v_add_f32 v248, v248, v228
    v_add_f32 v250, v250, v212
    v_exp_f32 v230, v214
    v_exp_f32_e64 v214, -v214
    v_add_f32 v248, v248, v229
    v_add_f32 v250, v250, v213
    s_setprio 2
    v_mfma_f32_32x32x16_bf16 v[176:191], v[44:47], v[140:143], v[176:191]
    ds_read_b64_tr_b16 v[136:137], v10 offset:20480
    ds_read_b64_tr_b16 v[138:139], v10 offset:20992
    ds_read_b64_tr_b16 v[140:141], v10 offset:22528
    ds_read_b64_tr_b16 v[142:143], v10 offset:23040
    v_exp_f32 v231, v215
    v_exp_f32_e64 v215, -v215
    v_add_f32 v248, v248, v230
    v_add_f32 v250, v250, v214
    v_exp_f32 v232, v216
    v_exp_f32_e64 v216, -v216
    s_setprio 1
    s_waitcnt lgkmcnt(6)
    v_mfma_f32_32x32x16_bf16 v[176:191], v[48:51], v[128:131], v[176:191]
    s_add_u32 m0, s14, 147456
    s_mov_b64 exec, s[90:91]
    buffer_load_dwordx4 v4, s[44:47], s88 offen lds
    s_mov_b64 exec, -1
    v_add_f32 v248, v248, v231
    v_add_f32 v250, v250, v215
    v_exp_f32 v233, v217
    v_exp_f32_e64 v217, -v217
    v_add_f32 v248, v248, v232
    v_add_f32 v250, v250, v216
    s_setprio 0
    s_waitcnt lgkmcnt(4)
    v_mfma_f32_32x32x16_bf16 v[176:191], v[52:55], v[132:135], v[176:191]
    s_waitcnt lgkmcnt(0)
    s_waitcnt vmcnt(2)
    s_barrier
    s_setprio 3
    v_mfma_f32_32x32x16_bf16 v[176:191], v[56:59], v[136:139], v[176:191]
    ds_read_b64_tr_b16 v[128:129], v10 offset:24576
    ds_read_b64_tr_b16 v[130:131], v10 offset:25088
    ds_read_b64_tr_b16 v[132:133], v10 offset:26624
    ds_read_b64_tr_b16 v[134:135], v10 offset:27136
    v_exp_f32 v234, v218
    v_exp_f32_e64 v218, -v218
    v_add_f32 v248, v248, v233
    v_add_f32 v250, v250, v217
    v_exp_f32 v235, v219
    v_exp_f32_e64 v219, -v219
    s_setprio 2
    v_mfma_f32_32x32x16_bf16 v[176:191], v[60:63], v[140:143], v[176:191]
    ds_read_b64_tr_b16 v[136:137], v10 offset:28672
    ds_read_b64_tr_b16 v[138:139], v10 offset:29184
    ds_read_b64_tr_b16 v[140:141], v10 offset:30720
    ds_read_b64_tr_b16 v[142:143], v10 offset:31232
    v_add_f32 v248, v248, v234
    v_add_f32 v250, v250, v218
    v_exp_f32 v236, v220
    v_exp_f32_e64 v220, -v220
    v_add_f32 v248, v248, v235
    v_add_f32 v250, v250, v219
    v_exp_f32 v237, v221
    s_setprio 1
    s_waitcnt lgkmcnt(6)
    v_mfma_f32_32x32x16_bf16 v[176:191], v[64:67], v[128:131], v[176:191]
    buffer_load_dword v254, v198, s[68:71], 0 offen sc1
    s_add_u32 m0, s14, 155648
    s_mov_b64 exec, s[90:91]
    buffer_load_dwordx4 v4, s[44:47], s89 offen lds
    s_mov_b64 exec, -1
    v_exp_f32_e64 v221, -v221
    v_fmac_f32 v248, v156, v236
    v_fmac_f32 v250, v156, v220
    v_exp_f32 v238, v222
    v_exp_f32_e64 v222, -v222
    s_setprio 0
    s_waitcnt lgkmcnt(4)
    v_mfma_f32_32x32x16_bf16 v[176:191], v[68:71], v[132:135], v[176:191]
    s_waitcnt lgkmcnt(0)
    s_waitcnt vmcnt(3)
    s_barrier
    s_setprio 3
    v_mfma_f32_32x32x16_bf16 v[176:191], v[72:75], v[136:139], v[176:191]
    ds_read_b64_tr_b16 v[128:129], v10 offset:32768
    ds_read_b64_tr_b16 v[130:131], v10 offset:33280
    ds_read_b64_tr_b16 v[132:133], v10 offset:34816
    ds_read_b64_tr_b16 v[134:135], v10 offset:35328
    v_fmac_f32 v248, v156, v237
    v_fmac_f32 v250, v156, v221
    v_exp_f32 v239, v223
    v_exp_f32_e64 v223, -v223
    v_fmac_f32 v248, v156, v238
    v_fmac_f32 v250, v156, v222
    v_fmac_f32 v248, v156, v239
    v_fmac_f32 v250, v156, v223
    s_setprio 2
    v_mfma_f32_32x32x16_bf16 v[176:191], v[76:79], v[140:143], v[176:191]
    ds_read_b64_tr_b16 v[136:137], v10 offset:36864
    ds_read_b64_tr_b16 v[138:139], v10 offset:37376
    ds_read_b64_tr_b16 v[140:141], v10 offset:38912
    ds_read_b64_tr_b16 v[142:143], v10 offset:39424
    v_permlane32_swap_b32 v248, v250
    v_add_f32 v248, v248, v250
    v_subrev_u32 v250, 0x21800000, v248
    v_cmp_lt_u32 vcc, 0x5a000000, v250
    s_nop 0
    s_cbranch_vccnz L_fms_k
L_fmr_k:
    v_rcp_f32 v196, v248
    s_nop 0
    v_mov_b32 v197, v196
    s_setprio 1
    s_waitcnt lgkmcnt(6)
    v_mfma_f32_32x32x16_bf16 v[176:191], v[80:83], v[128:131], v[176:191]
    s_add_u32 m0, s14, 106496
    s_mov_b64 exec, s[90:91]
    buffer_load_dwordx4 v5, s[44:47], s83 offen lds
    s_mov_b64 exec, -1
    v_permlane32_swap_b32 v196, v197
    v_mul_f32 v224, v196, v224
    v_mul_f32 v225, v196, v225
    v_mul_f32 v226, v196, v226
    v_mul_f32 v227, v196, v227
    v_cvt_pk_bf16_f32 v200, v224, v225
    v_cvt_pk_bf16_f32 v201, v226, v227
    s_setprio 0
    s_waitcnt lgkmcnt(4)
    v_mfma_f32_32x32x16_bf16 v[176:191], v[84:87], v[132:135], v[176:191]
    ds_write_b64 v144, v[200:201] offset:0
    s_waitcnt lgkmcnt(1)
    s_waitcnt vmcnt(3)
    s_barrier
    s_setprio 3
    v_mfma_f32_32x32x16_bf16 v[176:191], v[88:91], v[136:139], v[176:191]
    ds_read_b64_tr_b16 v[128:129], v10 offset:40960
    ds_read_b64_tr_b16 v[130:131], v10 offset:41472
    ds_read_b64_tr_b16 v[132:133], v10 offset:43008
    ds_read_b64_tr_b16 v[134:135], v10 offset:43520
    v_mul_f32 v228, v196, v228
    v_mul_f32 v229, v196, v229
    v_mul_f32 v230, v196, v230
    v_mul_f32 v231, v196, v231
    v_cvt_pk_bf16_f32 v202, v228, v229
    v_cvt_pk_bf16_f32 v203, v230, v231
    v_mul_f32 v232, v196, v232
    v_mul_f32 v233, v196, v233
    s_setprio 2
    v_mfma_f32_32x32x16_bf16 v[176:191], v[92:95], v[140:143], v[176:191]
    ds_read_b64_tr_b16 v[136:137], v10 offset:45056
    ds_read_b64_tr_b16 v[138:139], v10 offset:45568
    ds_read_b64_tr_b16 v[140:141], v10 offset:47104
    ds_read_b64_tr_b16 v[142:143], v10 offset:47616
    ds_write_b64 v2, v[202:203] offset:0
    v_mul_f32 v234, v196, v234
    v_mul_f32 v235, v196, v235
    v_cvt_pk_bf16_f32 v204, v232, v233
    v_cvt_pk_bf16_f32 v205, v234, v235
    v_mul_f32 v236, v196, v236
    v_mul_f32 v237, v196, v237
    v_mul_f32 v238, v196, v238
    s_setprio 1
    s_waitcnt lgkmcnt(7)
    v_mfma_f32_32x32x16_bf16 v[176:191], v[96:99], v[128:131], v[176:191]
    ds_write_b64 v3, v[204:205] offset:0
    s_add_u32 m0, s14, 114688
    s_mov_b64 exec, s[90:91]
    buffer_load_dwordx4 v5, s[44:47], s84 offen lds
    s_mov_b64 exec, -1
    v_mul_f32 v239, v196, v239
    v_cvt_pk_bf16_f32 v206, v236, v237
    v_cvt_pk_bf16_f32 v207, v238, v239
    v_mul_f32 v208, v197, v208
    v_mul_f32 v209, v197, v209
    v_mul_f32 v210, v197, v210
    v_mul_f32 v211, v197, v211
    s_setprio 0
    s_waitcnt lgkmcnt(6)
    v_mfma_f32_32x32x16_bf16 v[176:191], v[100:103], v[132:135], v[176:191]
    ds_write_b64 v6, v[206:207] offset:0
    s_waitcnt lgkmcnt(3)
    s_waitcnt vmcnt(2)
    s_barrier
    s_setprio 3
    v_mfma_f32_32x32x16_bf16 v[176:191], v[104:107], v[136:139], v[176:191]
    ds_read_b64_tr_b16 v[128:129], v10 offset:49152
    ds_read_b64_tr_b16 v[130:131], v10 offset:49664
    ds_read_b64_tr_b16 v[132:133], v10 offset:51200
    ds_read_b64_tr_b16 v[134:135], v10 offset:51712
    v_cvt_pk_bf16_f32 v224, v208, v209
    v_cvt_pk_bf16_f32 v225, v210, v211
    v_mul_f32 v212, v197, v212
    v_mul_f32 v213, v197, v213
    v_mul_f32 v214, v197, v214
    v_mul_f32 v215, v197, v215
    v_cvt_pk_bf16_f32 v226, v212, v213
    v_cvt_pk_bf16_f32 v227, v214, v215
    s_setprio 2
    v_mfma_f32_32x32x16_bf16 v[176:191], v[108:111], v[140:143], v[176:191]
    ds_read_b64_tr_b16 v[136:137], v10 offset:53248
    ds_read_b64_tr_b16 v[138:139], v10 offset:53760
    ds_read_b64_tr_b16 v[140:141], v10 offset:55296
    ds_read_b64_tr_b16 v[142:143], v10 offset:55808
    ds_write_b64 v7, v[224:225] offset:0
    v_mul_f32 v216, v197, v216
    v_mul_f32 v217, v197, v217
    v_mul_f32 v218, v197, v218
    v_mul_f32 v219, v197, v219
    v_cvt_pk_bf16_f32 v228, v216, v217
    v_cvt_pk_bf16_f32 v229, v218, v219
    s_setprio 1
    s_waitcnt lgkmcnt(7)
    v_mfma_f32_32x32x16_bf16 v[176:191], v[112:115], v[128:131], v[176:191]
    ds_write_b64 v8, v[226:227] offset:0
    ds_write_b64 v9, v[228:229] offset:0
    s_add_u32 m0, s14, 122880
    s_mov_b64 exec, s[90:91]
    buffer_load_dwordx4 v5, s[44:47], s85 offen lds
    s_mov_b64 exec, -1
    v_mul_f32 v220, v197, v220
    v_mul_f32 v221, v197, v221
    v_mul_f32 v222, v197, v222
    v_mul_f32 v223, v197, v223
    v_cvt_pk_bf16_f32 v230, v220, v221
    v_cvt_pk_bf16_f32 v231, v222, v223
    s_setprio 0
    s_waitcnt lgkmcnt(7)
    v_mfma_f32_32x32x16_bf16 v[176:191], v[116:119], v[132:135], v[176:191]
    ds_write_b64 v159, v[230:231] offset:0
    s_waitcnt lgkmcnt(4)
    v_mfma_f32_32x32x16_bf16 v[176:191], v[120:123], v[136:139], v[176:191]
    v_mfma_f32_32x32x16_bf16 v[176:191], v[124:127], v[140:143], v[176:191]
    s_mov_b32 s72, s48
    s_mov_b32 s73, s49
    s_mov_b32 s74, 0
    s_nop 8
    v_cvt_pk_bf16_f32 v208, v176, v177
    v_cvt_pk_bf16_f32 v209, v178, v179
    v_cvt_pk_bf16_f32 v210, v180, v181
    v_cvt_pk_bf16_f32 v211, v182, v183
    s_mov_b32 exec_lo, 0xefffffff
    s_mov_b32 exec_hi, 0xefffffff
    ds_write_b128 v154, v[208:211] offset:32768
    s_mov_b64 exec, -1
    v_cvt_pk_bf16_f32 v212, v184, v185
    v_cvt_pk_bf16_f32 v213, v186, v187
    v_cvt_pk_bf16_f32 v214, v188, v189
    v_cvt_pk_bf16_f32 v215, v190, v191
    s_mov_b32 exec_lo, 0xefffffff
    s_mov_b32 exec_hi, 0xefffffff
    ds_write_b128 v154, v[212:215] offset:33792
    s_mov_b64 exec, -1
    s_waitcnt lgkmcnt(0)
    s_barrier
    s_cmp_eq_u32 s8, 0
    s_cbranch_scc0 L_r_1
L_r_1b:
    ds_read_b64_tr_b16 v[208:209], v145 offset:0
    ds_read_b64_tr_b16 v[210:211], v146 offset:1024
    ds_read_b128 v[224:227], v147 offset:32768
    ds_read_b64_tr_b16 v[212:213], v145 offset:2048
    ds_read_b64_tr_b16 v[214:215], v146 offset:3072
    ds_read_b128 v[228:231], v147 offset:33792
    ds_read_b64_tr_b16 v[216:217], v145 offset:4096
    ds_read_b64_tr_b16 v[218:219], v146 offset:5120
    ds_read_b128 v[232:235], v147 offset:34816
    ds_read_b64_tr_b16 v[220:221], v145 offset:6144
    ds_read_b64_tr_b16 v[222:223], v146 offset:7168
    ds_read_b128 v[236:239], v147 offset:35840
    v_lshrrev_b32 v14, 1, v12
    s_waitcnt lgkmcnt(9)
    v_mfma_f32_32x32x16_bf16 v[176:191], v[208:211], v[224:227], 0
    ds_read_b64_tr_b16 v[208:209], v145 offset:8192
    ds_read_b64_tr_b16 v[210:211], v146 offset:9216
    ds_read_b128 v[224:227], v147 offset:36864
    s_waitcnt lgkmcnt(9)
    v_mfma_f32_32x32x16_bf16 v[176:191], v[212:215], v[228:231], v[176:191]
    ds_read_b64_tr_b16 v[212:213], v145 offset:10240
    ds_read_b64_tr_b16 v[214:215], v146 offset:11264
    ds_read_b128 v[228:231], v147 offset:37888
    s_waitcnt lgkmcnt(9)
    v_mfma_f32_32x32x16_bf16 v[176:191], v[216:219], v[232:235], v[176:191]
    ds_read_b64_tr_b16 v[216:217], v145 offset:12288
    ds_read_b64_tr_b16 v[218:219], v146 offset:13312
    ds_read_b128 v[232:235], v147 offset:38912
    s_waitcnt lgkmcnt(9)
    v_mfma_f32_32x32x16_bf16 v[176:191], v[220:223], v[236:239], v[176:191]
    ds_read_b64_tr_b16 v[220:221], v145 offset:14336
    ds_read_b64_tr_b16 v[222:223], v146 offset:15360
    ds_read_b128 v[236:239], v147 offset:39936
    s_waitcnt lgkmcnt(9)
    v_mfma_f32_32x32x16_bf16 v[176:191], v[208:211], v[224:227], v[176:191]
    s_waitcnt lgkmcnt(6)
    v_mfma_f32_32x32x16_bf16 v[176:191], v[212:215], v[228:231], v[176:191]
    s_waitcnt lgkmcnt(3)
    v_mfma_f32_32x32x16_bf16 v[176:191], v[216:219], v[232:235], v[176:191]
    s_waitcnt lgkmcnt(0)
    v_mfma_f32_32x32x16_bf16 v[176:191], v[220:223], v[236:239], v[176:191]
    s_nop 11
    v_cvt_pk_bf16_f32 v200, v176, v177
    v_cvt_pk_bf16_f32 v201, v178, v179
    v_cvt_pk_bf16_f32 v202, v180, v181
    v_cvt_pk_bf16_f32 v203, v182, v183
    buffer_store_dwordx4 v[200:203], v12, s[48:51], s39 offen offset:0 sc1
    v_cvt_pk_bf16_f32 v204, v184, v185
    v_cvt_pk_bf16_f32 v205, v186, v187
    v_cvt_pk_bf16_f32 v206, v188, v189
    v_cvt_pk_bf16_f32 v207, v190, v191
    s_mov_b32 exec_hi, 0
    buffer_store_dwordx4 v[204:207], v12, s[48:51], s39 offen offset:1024 sc1
    s_not_b64 exec, exec
    buffer_store_dwordx2 v[204:205], v14, s[48:51], s39 offen offset:1280 sc1
    s_mov_b64 exec, -1
    buffer_store_dword v200, off, s[72:75], 0 sc1
    s_branch L_pg_a_2_go
.p2align 12
L_pg_a_2_go:
L_kvdone:
    s_waitcnt vmcnt(4)
    s_barrier
    ds_read_b64_tr_b16 v[128:129], v10 offset:0
    ds_read_b64_tr_b16 v[130:131], v10 offset:512
    ds_read_b64_tr_b16 v[132:133], v10 offset:2048
    ds_read_b64_tr_b16 v[134:135], v10 offset:2560
    s_add_u32 m0, s14, 147456
    s_mov_b64 exec, s[90:91]
    buffer_load_dwordx4 v5, s[44:47], s88 offen lds
    s_mov_b64 exec, -1
    ds_read_b64_tr_b16 v[136:137], v10 offset:4096
    ds_read_b64_tr_b16 v[138:139], v10 offset:4608
    ds_read_b64_tr_b16 v[140:141], v10 offset:6144
    ds_read_b64_tr_b16 v[142:143], v10 offset:6656
    s_add_u32 m0, s76, s99
    s_mul_i32 s13, s76, 7
    buffer_load_dwordx4 v1, s[60:63], s13 offen lds
    s_waitcnt lgkmcnt(6)
    v_mfma_f32_32x32x16_bf16 v[160:175], v[128:131], v[16:19], 0
    s_waitcnt lgkmcnt(4)
    v_mfma_f32_32x32x16_bf16 v[160:175], v[132:135], v[20:23], v[160:175]
    s_waitcnt vmcnt(10)
    v_cmp_gt_u32 vcc, 1, v254
    s_nop 0
    s_cbranch_vccnz L_r_2
L_r_2b:
    v_mov_b32 v198, v194
    s_mov_b32 s68, s48
    s_mov_b32 s69, s49
    s_cmp_eq_u32 s3, 1
    s_cselect_b32 s70, 81920, 0
    s_cselect_b32 s9, 0, 64
    s_waitcnt lgkmcnt(0)
    v_mfma_f32_32x32x16_bf16 v[160:175], v[136:139], v[24:27], v[160:175]
    ds_read_b64_tr_b16 v[128:129], v10 offset:8192
    ds_read_b64_tr_b16 v[130:131], v10 offset:8704
    ds_read_b64_tr_b16 v[132:133], v10 offset:10240
    ds_read_b64_tr_b16 v[134:135], v10 offset:10752
    s_add_u32 m0, s14, 155648
    s_mov_b64 exec, s[90:91]
    buffer_load_dwordx4 v5, s[44:47], s89 offen lds
    s_mov_b64 exec, -1
    v_mfma_f32_32x32x16_bf16 v[160:175], v[140:143], v[28:31], v[160:175]
    ds_read_b64_tr_b16 v[136:137], v10 offset:12288
    ds_read_b64_tr_b16 v[138:139], v10 offset:12800
    ds_read_b64_tr_b16 v[140:141], v10 offset:14336
    ds_read_b64_tr_b16 v[142:143], v10 offset:14848
    s_add_u32 m0, s77, s99
    s_mul_i32 s13, s77, 7
    buffer_load_dwordx4 v1, s[60:63], s13 offen lds
    s_waitcnt lgkmcnt(6)
    v_mfma_f32_32x32x16_bf16 v[160:175], v[128:131], v[32:35], v[160:175]
    s_add_u32 m0, s78, s99
    s_mul_i32 s13, s78, 7
    buffer_load_dwordx4 v1, s[60:63], s13 offen lds
    s_waitcnt lgkmcnt(4)
    v_mfma_f32_32x32x16_bf16 v[160:175], v[132:135], v[36:39], v[160:175]
    s_waitcnt lgkmcnt(0)
    v_mfma_f32_32x32x16_bf16 v[160:175], v[136:139], v[40:43], v[160:175]
    ds_read_b64_tr_b16 v[128:129], v10 offset:16384
    ds_read_b64_tr_b16 v[130:131], v10 offset:16896
    ds_read_b64_tr_b16 v[132:133], v10 offset:18432
    ds_read_b64_tr_b16 v[134:135], v10 offset:18944
    v_mov_b32 v6, v252
    v_mov_b32 v7, v253
    v_mfma_f32_32x32x16_bf16 v[160:175], v[140:143], v[44:47], v[160:175]
    ds_read_b64_tr_b16 v[136:137], v10 offset:20480
    ds_read_b64_tr_b16 v[138:139], v10 offset:20992
    ds_read_b64_tr_b16 v[140:141], v10 offset:22528
    ds_read_b64_tr_b16 v[142:143], v10 offset:23040
    s_add_u32 m0, s79, s99
    s_mul_i32 s13, s79, 7
    buffer_load_dwordx4 v1, s[60:63], s13 offen lds
    v_mov_b32 v8, v158
    v_mov_b32 v9, v195
    s_waitcnt lgkmcnt(6)
    v_mfma_f32_32x32x16_bf16 v[160:175], v[128:131], v[48:51], v[160:175]
    v_mov_b32 v2, v192
    s_waitcnt lgkmcnt(4)
    v_mfma_f32_32x32x16_bf16 v[160:175], v[132:135], v[52:55], v[160:175]
    s_waitcnt lgkmcnt(0)
    s_waitcnt vmcnt(6)
    s_barrier
    v_mfma_f32_32x32x16_bf16 v[160:175], v[136:139], v[56:59], v[160:175]
    ds_read_b64_tr_b16 v[128:129], v10 offset:24576
    ds_read_b64_tr_b16 v[130:131], v10 offset:25088
    ds_read_b64_tr_b16 v[132:133], v10 offset:26624
    ds_read_b64_tr_b16 v[134:135], v10 offset:27136
    s_lshl_b32 s10, s5, 11
    s_mov_b64 exec, 0xffff
    buffer_atomic_add v255, v193, s[40:43], s10 offen sc1
    s_mov_b64 exec, -1
    v_mfma_f32_32x32x16_bf16 v[160:175], v[140:143], v[60:63], v[160:175]
    ds_read_b64_tr_b16 v[136:137], v10 offset:28672
    ds_read_b64_tr_b16 v[138:139], v10 offset:29184
    ds_read_b64_tr_b16 v[140:141], v10 offset:30720
    ds_read_b64_tr_b16 v[142:143], v10 offset:31232
    s_add_u32 m0, s80, s99
    s_mul_i32 s13, s80, 7
    buffer_load_dwordx4 v1, s[60:63], s13 offen lds
    s_waitcnt lgkmcnt(6)
    v_mfma_f32_32x32x16_bf16 v[160:175], v[128:131], v[64:67], v[160:175]
    s_waitcnt lgkmcnt(4)
    v_mfma_f32_32x32x16_bf16 v[160:175], v[132:135], v[68:71], v[160:175]
    s_waitcnt lgkmcnt(0)
    v_mfma_f32_32x32x16_bf16 v[160:175], v[136:139], v[72:75], v[160:175]
    ds_read_b64_tr_b16 v[128:129], v10 offset:32768
    ds_read_b64_tr_b16 v[130:131], v10 offset:33280
    ds_read_b64_tr_b16 v[132:133], v10 offset:34816
    ds_read_b64_tr_b16 v[134:135], v10 offset:35328
    v_min_u32 v13, 62, v0
    v_lshl_add_u32 v13, v13, 3, 64
    v_add_u32 v13, 192, v13
    v_mfma_f32_32x32x16_bf16 v[160:175], v[140:143], v[76:79], v[160:175]
    ds_read_b64_tr_b16 v[136:137], v10 offset:36864
    ds_read_b64_tr_b16 v[138:139], v10 offset:37376
    ds_read_b64_tr_b16 v[140:141], v10 offset:38912
    ds_read_b64_tr_b16 v[142:143], v10 offset:39424
    s_add_u32 m0, s81, s99
    s_mul_i32 s13, s81, 7
    buffer_load_dwordx4 v1, s[60:63], s13 offen lds
    s_and_b32 s10, s3, 1
    s_sub_u32 s10, s10, 1
    v_or_b32 v14, s10, v11
    s_waitcnt lgkmcnt(6)
    v_mfma_f32_32x32x16_bf16 v[160:175], v[128:131], v[80:83], v[160:175]
    v_bfi_b32 v144, v14, v12, v13
    s_waitcnt lgkmcnt(4)
    v_mfma_f32_32x32x16_bf16 v[160:175], v[132:135], v[84:87], v[160:175]
    s_waitcnt lgkmcnt(0)
    s_waitcnt vmcnt(6)
    s_barrier
    v_mfma_f32_32x32x16_bf16 v[160:175], v[136:139], v[88:91], v[160:175]
    ds_read_b64_tr_b16 v[128:129], v10 offset:40960
    ds_read_b64_tr_b16 v[130:131], v10 offset:41472
    ds_read_b64_tr_b16 v[132:133], v10 offset:43008
    ds_read_b64_tr_b16 v[134:135], v10 offset:43520
    v_mfma_f32_32x32x16_bf16 v[160:175], v[140:143], v[92:95], v[160:175]
    ds_read_b64_tr_b16 v[136:137], v10 offset:45056
    ds_read_b64_tr_b16 v[138:139], v10 offset:45568
    ds_read_b64_tr_b16 v[140:141], v10 offset:47104
    ds_read_b64_tr_b16 v[142:143], v10 offset:47616
    s_add_u32 m0, s82, s99
    s_mul_i32 s13, s82, 7
    buffer_load_dwordx4 v1, s[60:63], s13 offen lds
    s_waitcnt lgkmcnt(6)
    v_mfma_f32_32x32x16_bf16 v[160:175], v[128:131], v[96:99], v[160:175]
    s_waitcnt lgkmcnt(4)
    v_mfma_f32_32x32x16_bf16 v[160:175], v[132:135], v[100:103], v[160:175]
    s_waitcnt lgkmcnt(0)
    v_mfma_f32_32x32x16_bf16 v[160:175], v[136:139], v[104:107], v[160:175]
    ds_read_b64_tr_b16 v[128:129], v10 offset:49152
    ds_read_b64_tr_b16 v[130:131], v10 offset:49664
    ds_read_b64_tr_b16 v[132:133], v10 offset:51200
    ds_read_b64_tr_b16 v[134:135], v10 offset:51712
    v_mfma_f32_32x32x16_bf16 v[160:175], v[140:143], v[108:111], v[160:175]
    ds_read_b64_tr_b16 v[136:137], v10 offset:53248
    ds_read_b64_tr_b16 v[138:139], v10 offset:53760
    ds_read_b64_tr_b16 v[140:141], v10 offset:55296
    ds_read_b64_tr_b16 v[142:143], v10 offset:55808
    s_waitcnt lgkmcnt(6)
    v_mfma_f32_32x32x16_bf16 v[160:175], v[128:131], v[112:115], v[160:175]
    s_waitcnt lgkmcnt(4)
    v_mfma_f32_32x32x16_bf16 v[160:175], v[132:135], v[116:119], v[160:175]
    v_mov_b32 v254, 64
    s_mov_b64 exec, 1
    v_mov_b32 v254, 0
    buffer_atomic_or v254, v198, s[68:71], 0 offen sc0 sc1
    s_mov_b64 exec, -1
    s_waitcnt lgkmcnt(0)
    v_mfma_f32_32x32x16_bf16 v[160:175], v[136:139], v[120:123], v[160:175]
    v_mfma_f32_32x32x16_bf16 v[160:175], v[140:143], v[124:127], v[160:175]
    s_nop 11
    v_mul_f32 v192, 0xbfb8aa3b, v172
    v_mul_f32 v160, v157, v160
    v_mul_f32 v161, v157, v161
    v_mul_f32 v162, v157, v162
    v_mul_f32 v163, v157, v163
    v_cvt_pk_bf16_f32 v200, v160, v161
    v_mul_f32 v164, v157, v164
    v_mul_f32 v165, v157, v165
    v_cvt_pk_bf16_f32 v201, v162, v163
    v_mul_f32 v166, v157, v166
    v_mul_f32 v167, v157, v167
    v_cvt_pk_bf16_f32 v202, v164, v165
    v_mul_f32 v168, v157, v168
    v_mul_f32 v169, v157, v169
    v_cvt_pk_bf16_f32 v203, v166, v167
    v_mul_f32 v170, v157, v170
    v_mul_f32 v171, v157, v171
    v_cvt_pk_bf16_f32 v204, v168, v169
    v_mul_f32 v172, v157, v172
    v_mul_f32 v173, v157, v173
    v_cvt_pk_bf16_f32 v205, v170, v171
    v_mul_f32 v174, v157, v174
    v_mul_f32 v175, v157, v175
    v_cvt_pk_bf16_f32 v206, v172, v173
    v_cvt_pk_bf16_f32 v207, v174, v175
    v_and_b32 v206, v11, v206
    v_and_b32 v207, v11, v207
    v_mfma_f32_32x32x16_bf16 v[208:223], v[240:243], v[200:203], 0
    s_nop 0
    v_mfma_f32_32x32x16_bf16 v[208:223], v[244:247], v[204:207], v[208:223]
    v_exp_f32 v192, v192
    s_nop 0
    v_add_f32 v192, 1.0, v192
    s_waitcnt vmcnt(0)
    v_or_b32 v254, s9, v254
    v_cmp_gt_u32 vcc, 16, v254
    s_nop 0
    s_cbranch_vccnz L_r_3
L_r_3b:
    s_barrier
    s_add_u32 s12, s6, 0
    s_and_b32 s12, s12, 3
    s_mul_i32 s12, s12, 16384
    s_add_u32 s12, s12, s1
    buffer_load_dwordx4 v[48:51], v144, s[48:51], s12 offen sc1
    s_add_u32 s12, s12, 4096
    buffer_load_dwordx4 v[52:55], v144, s[48:51], s12 offen sc1
    s_add_u32 s12, s12, 4096
    buffer_load_dwordx4 v[56:59], v144, s[48:51], s12 offen sc1
    s_add_u32 s12, s12, 4096
    buffer_load_dwordx4 v[60:63], v144, s[48:51], s12 offen sc1
    v_exp_f32 v224, v208
    v_exp_f32_e64 v208, -v208
    v_exp_f32 v225, v209
    v_exp_f32_e64 v209, -v209
    v_exp_f32 v226, v210
    v_exp_f32_e64 v210, -v210
    v_add_f32 v248, v224, v225
    v_add_f32 v250, v208, v209
    v_exp_f32 v227, v211
    v_exp_f32_e64 v211, -v211
    v_add_f32 v248, v248, v226
    v_add_f32 v250, v250, v210
    v_exp_f32 v228, v212
    v_exp_f32_e64 v212, -v212
    v_add_f32 v248, v248, v227
    v_add_f32 v250, v250, v211
    v_exp_f32 v229, v213
    v_exp_f32_e64 v213, -v213
    v_add_f32 v248, v248, v228
    v_add_f32 v250, v250, v212
    v_exp_f32 v230, v214
    v_exp_f32_e64 v214, -v214
    v_add_f32 v248, v248, v229
    v_add_f32 v250, v250, v213
    v_exp_f32 v231, v215
    v_exp_f32_e64 v215, -v215
    v_add_f32 v248, v248, v230
    v_add_f32 v250, v250, v214
    v_exp_f32 v232, v216
    v_exp_f32_e64 v216, -v216
    v_add_f32 v248, v248, v231
    v_add_f32 v250, v250, v215
    v_exp_f32 v233, v217
    v_exp_f32_e64 v217, -v217
    v_add_f32 v248, v248, v232
    v_add_f32 v250, v250, v216
    v_exp_f32 v234, v218
    v_exp_f32_e64 v218, -v218
    v_add_f32 v248, v248, v233
    v_add_f32 v250, v250, v217
    v_exp_f32 v235, v219
    v_exp_f32_e64 v219, -v219
    s_waitcnt vmcnt(3)
    v_mfma_f32_32x32x16_bf16 v[176:191], v[148:151], v[48:51], 0
    s_add_u32 s12, s6, 1
    s_and_b32 s12, s12, 3
    s_mul_i32 s12, s12, 16384
    s_add_u32 s12, s12, s1
    buffer_load_dwordx4 v[64:67], v144, s[48:51], s12 offen sc1
    v_add_f32 v248, v248, v234
    v_add_f32 v250, v250, v218
    v_exp_f32 v236, v220
    v_exp_f32_e64 v220, -v220
    v_add_f32 v248, v248, v235
    v_add_f32 v250, v250, v219
    s_waitcnt vmcnt(3)
    v_mfma_f32_32x32x16_bf16 v[176:191], v[148:151], v[52:55], v[176:191]
    s_add_u32 s12, s12, 4096
    buffer_load_dwordx4 v[68:71], v144, s[48:51], s12 offen sc1
    v_exp_f32 v237, v221
    v_exp_f32_e64 v221, -v221
    v_fmac_f32 v248, v156, v236
    v_fmac_f32 v250, v156, v220
    v_exp_f32 v238, v222
    v_exp_f32_e64 v222, -v222
    s_waitcnt vmcnt(3)
    v_mfma_f32_32x32x16_bf16 v[176:191], v[148:151], v[56:59], v[176:191]
    s_add_u32 s12, s12, 4096
    buffer_load_dwordx4 v[72:75], v144, s[48:51], s12 offen sc1
    v_fmac_f32 v248, v156, v237
    v_fmac_f32 v250, v156, v221
    v_exp_f32 v239, v223
    v_exp_f32_e64 v223, -v223
    v_fmac_f32 v248, v156, v238
    v_fmac_f32 v250, v156, v222
    s_waitcnt vmcnt(3)
    v_mfma_f32_32x32x16_bf16 v[176:191], v[148:151], v[60:63], v[176:191]
    s_add_u32 s12, s12, 4096
    buffer_load_dwordx4 v[76:79], v144, s[48:51], s12 offen sc1
    v_fmac_f32 v248, v156, v239
    v_fmac_f32 v250, v156, v223
    s_nop 1
    v_permlane32_swap_b32 v248, v250
    v_add_f32 v248, v248, v250
    v_subrev_u32 v250, 0x21800000, v248
    v_cmp_lt_u32 vcc, 0x5a000000, v250
    s_nop 0
    s_cbranch_vccnz L_fms_q
L_fmr_q:
    v_rcp_f32 v196, v248
    s_waitcnt vmcnt(3)
    v_mfma_f32_32x32x16_bf16 v[176:191], v[148:151], v[64:67], v[176:191]
    s_add_u32 s12, s6, 2
    s_and_b32 s12, s12, 3
    s_mul_i32 s12, s12, 16384
    s_add_u32 s12, s12, s1
    buffer_load_dwordx4 v[80:83], v144, s[48:51], s12 offen sc1
    v_mov_b32 v197, v196
    s_nop 1
    v_permlane32_swap_b32 v196, v197
    v_mul_f32 v224, v196, v224
    v_mul_f32 v225, v196, v225
    v_mul_f32 v226, v196, v226
    v_mul_f32 v227, v196, v227
    v_cvt_pk_bf16_f32 v16, v224, v225
    v_cvt_pk_bf16_f32 v17, v226, v227
    v_mul_f32 v228, v196, v228
    s_waitcnt vmcnt(3)
    v_mfma_f32_32x32x16_bf16 v[176:191], v[148:151], v[68:71], v[176:191]
    s_add_u32 s12, s12, 4096
    buffer_load_dwordx4 v[84:87], v144, s[48:51], s12 offen sc1
    v_mul_f32 v229, v196, v229
    v_mul_f32 v230, v196, v230
    v_mul_f32 v231, v196, v231
    v_cvt_pk_bf16_f32 v18, v228, v229
    v_cvt_pk_bf16_f32 v19, v230, v231
    v_mul_f32 v232, v196, v232
    v_mul_f32 v233, v196, v233
    v_mul_f32 v234, v196, v234
    v_mul_f32 v235, v196, v235
    s_waitcnt vmcnt(3)
    v_mfma_f32_32x32x16_bf16 v[176:191], v[148:151], v[72:75], v[176:191]
    s_add_u32 s12, s12, 4096
    buffer_load_dwordx4 v[88:91], v144, s[48:51], s12 offen sc1
    v_cvt_pk_bf16_f32 v20, v232, v233
    v_cvt_pk_bf16_f32 v21, v234, v235
    v_mul_f32 v236, v196, v236
    v_mul_f32 v237, v196, v237
    v_mul_f32 v238, v196, v238
    v_mul_f32 v239, v196, v239
    v_cvt_pk_bf16_f32 v22, v236, v237
    v_cvt_pk_bf16_f32 v23, v238, v239
    v_and_b32 v22, v11, v22
    s_waitcnt vmcnt(3)
    v_mfma_f32_32x32x16_bf16 v[176:191], v[148:151], v[76:79], v[176:191]
    s_add_u32 s12, s12, 4096
    buffer_load_dwordx4 v[92:95], v144, s[48:51], s12 offen sc1
    v_and_b32 v23, v11, v23
    v_mul_f32 v208, v197, v208
    v_mul_f32 v209, v197, v209
    v_mul_f32 v210, v197, v210
    v_mul_f32 v211, v197, v211
    v_cvt_pk_bf16_f32 v24, v208, v209
    v_cvt_pk_bf16_f32 v25, v210, v211
    v_mul_f32 v212, v197, v212
    v_mul_f32 v213, v197, v213
    s_waitcnt vmcnt(3)
    v_mfma_f32_32x32x16_bf16 v[176:191], v[148:151], v[80:83], v[176:191]
    s_add_u32 s12, s6, 3
    s_and_b32 s12, s12, 3
    s_mul_i32 s12, s12, 16384
    s_add_u32 s12, s12, s1
    buffer_load_dwordx4 v[96:99], v144, s[48:51], s12 offen sc1
    v_mul_f32 v214, v197, v214
    v_mul_f32 v215, v197, v215
    v_cvt_pk_bf16_f32 v26, v212, v213
    v_cvt_pk_bf16_f32 v27, v214, v215
    v_mul_f32 v216, v197, v216
    v_mul_f32 v217, v197, v217
    v_mul_f32 v218, v197, v218
    v_mul_f32 v219, v197, v219
    v_cvt_pk_bf16_f32 v28, v216, v217
    s_waitcnt vmcnt(3)
    v_mfma_f32_32x32x16_bf16 v[176:191], v[148:151], v[84:87], v[176:191]
    s_add_u32 s12, s12, 4096
    buffer_load_dwordx4 v[100:103], v144, s[48:51], s12 offen sc1
    v_cvt_pk_bf16_f32 v29, v218, v219
    v_mul_f32 v220, v197, v220
    v_mul_f32 v221, v197, v221
    v_mul_f32 v222, v197, v222
    v_mul_f32 v223, v197, v223
    v_cvt_pk_bf16_f32 v30, v220, v221
    v_cvt_pk_bf16_f32 v31, v222, v223
    v_and_b32 v30, v11, v30
    v_and_b32 v31, v11, v31
    s_waitcnt vmcnt(3)
    v_mfma_f32_32x32x16_bf16 v[176:191], v[148:151], v[88:91], v[176:191]
    s_add_u32 s12, s12, 4096
    buffer_load_dwordx4 v[104:107], v144, s[48:51], s12 offen sc1
    s_waitcnt vmcnt(3)
    v_mfma_f32_32x32x16_bf16 v[176:191], v[148:151], v[92:95], v[176:191]
    s_add_u32 s12, s12, 4096
    buffer_load_dwordx4 v[108:111], v144, s[48:51], s12 offen sc1
    s_waitcnt vmcnt(3)
    v_mfma_f32_32x32x16_bf16 v[176:191], v[148:151], v[96:99], v[176:191]
    s_add_u32 s13, s95, 0
    s_and_b32 s13, s13, 3
    s_add_u32 s13, s13, 3
    s_lshl_b32 s13, s13, 13
    s_add_u32 m0, s13, s98
    s_mul_i32 s13, s13, 7
    buffer_load_dwordx4 v1, s[64:67], s13 offen lds
    s_waitcnt vmcnt(3)
    v_mfma_f32_32x32x16_bf16 v[176:191], v[148:151], v[100:103], v[176:191]
    s_add_u32 s13, s95, 1
    s_and_b32 s13, s13, 3
    s_add_u32 s13, s13, 3
    s_lshl_b32 s13, s13, 13
    s_add_u32 m0, s13, s98
    s_mul_i32 s13, s13, 7
    buffer_load_dwordx4 v1, s[64:67], s13 offen lds
    s_waitcnt vmcnt(3)
    v_mfma_f32_32x32x16_bf16 v[176:191], v[148:151], v[104:107], v[176:191]
    s_waitcnt vmcnt(2)
    v_mfma_f32_32x32x16_bf16 v[176:191], v[148:151], v[108:111], v[176:191]
    s_nop 11
    v_cvt_pk_bf16_f32 v200, v176, v177
    v_cvt_pk_bf16_f32 v201, v178, v179
    v_cvt_pk_bf16_f32 v202, v180, v181
    v_cvt_pk_bf16_f32 v203, v182, v183
    ds_write_b128 v152, v[200:203] offset:0
    s_waitcnt lgkmcnt(0)
    s_barrier
    ds_read_b128 v[48:51], v153 offset:0
    ds_read_b128 v[52:55], v153 offset:1024
    ds_read_b128 v[56:59], v153 offset:2048
    ds_read_b128 v[60:63], v153 offset:3072
    s_waitcnt lgkmcnt(3)
    v_mfma_f32_32x32x16_bf16 v[160:175], v[48:51], v[16:19], 0
    s_waitcnt lgkmcnt(2)
    v_mfma_f32_32x32x16_bf16 v[160:175], v[52:55], v[20:23], v[160:175]
    s_waitcnt lgkmcnt(1)
    v_mfma_f32_32x32x16_bf16 v[160:175], v[56:59], v[24:27], v[160:175]
    s_waitcnt lgkmcnt(0)
    v_mfma_f32_32x32x16_bf16 v[160:175], v[60:63], v[28:31], v[160:175]
    s_nop 11
    v_add_f32 v13, 0x358637bd, v172
    v_mul_f32 v13, v192, v13
    v_rcp_f32 v196, v13
    v_lshrrev_b32 v14, 1, v12
    v_mov_b32 v197, v196
    s_nop 1
    v_permlane32_swap_b32 v196, v197
    v_mul_f32 v160, v197, v160
    v_mul_f32 v161, v197, v161
    v_mul_f32 v162, v197, v162
    v_mul_f32 v163, v197, v163
    v_mul_f32 v164, v197, v164
    v_mul_f32 v165, v197, v165
    v_mul_f32 v166, v197, v166
    v_mul_f32 v167, v197, v167
    v_cvt_pk_bf16_f32 v200, v160, v161
    v_cvt_pk_bf16_f32 v201, v162, v163
    v_cvt_pk_bf16_f32 v202, v164, v165
    v_cvt_pk_bf16_f32 v203, v166, v167
    buffer_store_dwordx4 v[200:203], v12, s[48:51], s93 offen offset:0 sc1
    v_mul_f32 v168, v197, v168
    v_mul_f32 v169, v197, v169
    v_mul_f32 v170, v197, v170
    v_mul_f32 v171, v197, v171
    v_mul_f32 v172, v197, v172
    v_mul_f32 v173, v197, v173
    v_mul_f32 v174, v197, v174
    v_mul_f32 v175, v197, v175
    v_cvt_pk_bf16_f32 v204, v168, v169
    v_cvt_pk_bf16_f32 v205, v170, v171
    v_cvt_pk_bf16_f32 v206, v172, v173
    v_cvt_pk_bf16_f32 v207, v174, v175
    s_mov_b32 exec_hi, 0
    buffer_store_dwordx4 v[204:207], v12, s[48:51], s93 offen offset:1024 sc1
    s_not_b64 exec, exec
    buffer_store_dwordx2 v[204:205], v14, s[48:51], s93 offen offset:1280 sc1
    s_mov_b64 exec, -1
    s_branch L_join
L_r_1:
    v_subrev_u32 v13, 86016, v5
    s_mov_b64 exec, s[90:91]
    s_add_u32 m0, s14, 131072
    s_nop 0
    buffer_load_dwordx4 v5, s[44:47], s86 offen lds
    s_add_u32 m0, s14, 126976
    s_nop 0
    buffer_load_dwordx4 v13, s[44:47], s86 offen lds
    s_add_u32 m0, s14, 139264
    s_nop 0
    buffer_load_dwordx4 v5, s[44:47], s87 offen lds
    s_add_u32 m0, s14, 135168
    s_nop 0
    buffer_load_dwordx4 v13, s[44:47], s87 offen lds
    s_mov_b64 exec, -1
    s_branch L_kvdone
    s_branch L_r_1b
L_r_2:
    s_mov_b32 s94, 0
L_pl_4:
    buffer_load_dword v254, v198, s[68:71], 0 offen sc1
    s_add_u32 s94, s94, 1
    s_waitcnt vmcnt(0)
    v_cmp_gt_u32 vcc, 1, v254
    s_cmp_lt_u32 s94, 0x8000
    s_cbranch_scc0 L_pd_5
    s_cbranch_vccnz L_pl_4
L_pd_5:
    s_branch L_r_2b
L_r_3:
    s_mov_b32 s94, 0
L_pl_6:
    v_mov_b32 v254, 64
    s_mov_b64 exec, 1
    v_mov_b32 v254, 0
    buffer_atomic_or v254, v198, s[68:71], 0 offen sc0 sc1
    s_mov_b64 exec, -1
    s_add_u32 s94, s94, 1
    s_waitcnt vmcnt(0)
    v_cmp_gt_u32 vcc, 16, v254
    s_cmp_lt_u32 s94, 0x8000
    s_cbranch_scc0 L_pd_7
    s_cbranch_vccnz L_pl_6
L_pd_7:
    s_branch L_r_3b
.p2align 12
L_path_b:
    s_cmp_eq_u32 s5, 7
    s_cbranch_scc1 L_r_8
L_r_8b:
    s_lshl_b32 s10, s8, 6
    v_and_b32 v14, 1, v0
    v_bfe_u32 v13, v0, 1, 1
    v_lshl_or_b32 v13, v14, 1, v13
    v_bfe_u32 v15, v0, 4, 1
    v_lshl_or_b32 v13, v15, 2, v13
    v_lshl_add_u32 v13, v13, 3, s10
    v_bfe_u32 v15, v0, 3, 1
    v_lshlrev_b32 v15, 6, v15
    v_xor_b32 v13, v15, v13
    v_bfe_u32 v15, v0, 2, 1
    v_lshlrev_b32 v15, 4, v15
    v_xor_b32 v13, v15, v13
    v_and_b32 v15, 32, v0
    v_xor_b32 v13, v15, v13
    v_lshl_add_u32 v13, v15, 5, v13
    v_bfe_u32 v15, v0, 2, 2
    v_lshl_add_u32 v13, v15, 7, v13
    v_add_u32 v10, 49152, v13
    v_and_b32 v13, 3, v0
    v_bfe_u32 v15, v0, 4, 1
    v_lshl_add_u32 v13, v15, 2, v13
    v_lshl_add_u32 v13, v13, 3, s10
    v_bfe_u32 v15, v0, 3, 1
    v_lshlrev_b32 v15, 6, v15
    v_xor_b32 v13, v15, v13
    v_bfe_u32 v15, v0, 2, 1
    v_lshlrev_b32 v15, 4, v15
    v_xor_b32 v13, v15, v13
    v_and_b32 v15, 32, v0
    v_xor_b32 v13, v15, v13
    v_lshl_add_u32 v13, v15, 5, v13
    v_bfe_u32 v15, v0, 2, 2
    v_lshl_add_u32 v13, v15, 7, v13
    v_add_u32 v4, 106496, v13
    s_cmp_ge_u32 s3, 4
    s_cselect_b32 s10, 49152, 0
    s_sub_u32 s10, 16384, s10
    s_cmp_ge_u32 s3, 6
    s_cselect_b32 s10, 49152, s10
    s_sub_u32 s10, s10, 106496
    v_add_u32 v199, s10, v199
    s_lshl2_add_u32 s10, s6, s7
    s_mul_i32 s39, s10, 28672
    v_and_b32 v13, 1, v0
    v_sub_u32 v13, s5, v13
    v_med3_i32 v13, v13, 0, 6
    v_bfe_u32 v14, v0, 1, 2
    s_min_u32 s10, s6, 2
    v_min_u32 v14, s10, v14
    v_sub_u32 v14, s6, v14
    v_lshl_add_u32 v13, v13, 4, v14
    v_add_u32 v13, 128, v13
    v_lshlrev_b32 v194, 7, v13
    v_and_b32 v14, 1, v0
    v_bfe_u32 v13, v0, 1, 1
    v_lshl_or_b32 v13, v14, 1, v13
    v_bfe_u32 v15, v0, 4, 1
    v_lshl_or_b32 v13, v15, 2, v13
    v_add_u32 v14, 1, v13
    v_and_b32 v14, 8, v14
    v_or_b32 v13, v13, v14
    v_lshlrev_b32 v13, 3, v13
    v_lshlrev_b32 v14, 6, s8
    v_xor_b32 v13, v14, v13
    v_bfe_u32 v15, v0, 3, 1
    v_lshlrev_b32 v15, 6, v15
    v_xor_b32 v13, v15, v13
    v_bfe_u32 v15, v0, 2, 1
    v_lshlrev_b32 v15, 4, v15
    v_xor_b32 v13, v15, v13
    v_and_b32 v15, 32, v0
    v_xor_b32 v13, v15, v13
    v_lshl_add_u32 v13, v15, 5, v13
    v_bfe_u32 v15, v0, 2, 2
    v_lshl_add_u32 v13, v15, 7, v13
    v_add_u32 v196, 0, v13
    v_lshrrev_b32 v13, 5, v0
    v_mul_u32_u24 v13, 6656, v13
    v_add_u32 v197, v13, v12
    v_and_b32 v13, 31, v0
    v_lshlrev_b32 v13, v13, -2
    v_lshrrev_b32 v15, 3, v0
    v_and_b32 v15, 4, v15
    v_lshrrev_b32 v195, v15, v13
    v_bfe_i32 v208, v195, 0, 1
    v_lshlrev_b32 v208, 23, v208
    v_xor_b32 v224, 0xff800000, v208
    v_bfe_i32 v209, v195, 1, 1
    v_lshlrev_b32 v209, 23, v209
    v_xor_b32 v225, 0xff800000, v209
    v_bfe_i32 v210, v195, 2, 1
    v_lshlrev_b32 v210, 23, v210
    v_xor_b32 v226, 0xff800000, v210
    v_bfe_i32 v211, v195, 3, 1
    v_lshlrev_b32 v211, 23, v211
    v_xor_b32 v227, 0xff800000, v211
    v_bfe_i32 v212, v195, 8, 1
    v_lshlrev_b32 v212, 23, v212
    v_xor_b32 v228, 0xff800000, v212
    v_bfe_i32 v213, v195, 9, 1
    v_lshlrev_b32 v213, 23, v213
    v_xor_b32 v229, 0xff800000, v213
    v_bfe_i32 v214, v195, 10, 1
    v_lshlrev_b32 v214, 23, v214
    v_xor_b32 v230, 0xff800000, v214
    v_bfe_i32 v215, v195, 11, 1
    v_lshlrev_b32 v215, 23, v215
    v_xor_b32 v231, 0xff800000, v215
    v_bfe_i32 v216, v195, 16, 1
    v_lshlrev_b32 v216, 23, v216
    v_xor_b32 v232, 0xff800000, v216
    v_bfe_i32 v217, v195, 17, 1
    v_lshlrev_b32 v217, 23, v217
    v_xor_b32 v233, 0xff800000, v217
    v_bfe_i32 v218, v195, 18, 1
    v_lshlrev_b32 v218, 23, v218
    v_xor_b32 v234, 0xff800000, v218
    v_bfe_i32 v219, v195, 19, 1
    v_lshlrev_b32 v219, 23, v219
    v_xor_b32 v235, 0xff800000, v219
    v_bfe_i32 v220, v195, 24, 1
    v_lshlrev_b32 v220, 23, v220
    v_xor_b32 v236, 0xff800000, v220
    v_bfe_i32 v221, v195, 25, 1
    v_lshlrev_b32 v221, 23, v221
    v_xor_b32 v237, 0xff800000, v221
    v_bfe_i32 v222, v195, 26, 1
    v_lshlrev_b32 v222, 23, v222
    v_xor_b32 v238, 0xff800000, v222
    v_bfe_i32 v223, v195, 27, 1
    v_lshlrev_b32 v223, 23, v223
    v_xor_b32 v239, 0xff800000, v223
    s_mov_b32 s35, 0x20000
    s_lshl3_add_u32 s10, s3, s5
    s_cmp_eq_u32 s10, 31
    s_cbranch_scc1 L_r_9
L_r_9b:
    s_cmp_eq_u32 s5, 7
    s_cbranch_scc1 L_r_10
L_r_10b:
    s_add_u32 m0, s15, 17408
    s_nop 0
    buffer_load_dwordx4 v2, s[40:43], s77 offen lds
    s_add_u32 m0, s99, 65536
    s_nop 0
    buffer_load_dwordx4 v3, s[72:75], s84 offen lds
    s_waitcnt vmcnt(3)
    s_barrier
    ds_read_b128 v[16:19], v6 offset:0
    ds_read_b64_tr_b16 v[128:129], v10 offset:0
    ds_read_b64_tr_b16 v[130:131], v10 offset:512
    ds_read_b128 v[20:23], v7 offset:0
    ds_read_b64_tr_b16 v[132:133], v10 offset:2048
    ds_read_b64_tr_b16 v[134:135], v10 offset:2560
    s_add_u32 m0, s14, 105600
    s_nop 0
    buffer_load_dwordx4 v3, s[72:75], s83 offen offset:896 lds
    ds_read_b128 v[24:27], v8 offset:0
    ds_read_b64_tr_b16 v[136:137], v10 offset:4096
    ds_read_b64_tr_b16 v[138:139], v10 offset:4608
    ds_read_b128 v[28:31], v9 offset:0
    ds_read_b64_tr_b16 v[140:141], v10 offset:6144
    ds_read_b64_tr_b16 v[142:143], v10 offset:6656
    s_add_u32 m0, s15, 32768
    s_nop 0
    buffer_load_dwordx4 v1, s[40:43], s78 offen lds
    s_waitcnt lgkmcnt(9)
    v_mfma_f32_32x32x16_bf16 v[160:175], v[128:131], v[16:19], 0
    s_add_u32 m0, s15, 33792
    s_nop 0
    buffer_load_dwordx4 v2, s[40:43], s78 offen lds
    s_waitcnt lgkmcnt(6)
    v_mfma_f32_32x32x16_bf16 v[160:175], v[132:135], v[20:23], v[160:175]
    s_add_u32 m0, s99, 81920
    s_nop 0
    buffer_load_dwordx4 v3, s[72:75], s85 offen lds
    s_waitcnt lgkmcnt(0)
    s_waitcnt vmcnt(4)
    s_barrier
    v_mfma_f32_32x32x16_bf16 v[160:175], v[136:139], v[24:27], v[160:175]
    ds_read_b128 v[32:35], v6 offset:16384
    ds_read_b64_tr_b16 v[128:129], v10 offset:16384
    ds_read_b64_tr_b16 v[130:131], v10 offset:16896
    ds_read_b128 v[36:39], v7 offset:16384
    ds_read_b64_tr_b16 v[132:133], v10 offset:18432
    ds_read_b64_tr_b16 v[134:135], v10 offset:18944
    s_add_u32 m0, s14, 113792
    s_nop 0
    buffer_load_dwordx4 v3, s[72:75], s84 offen offset:896 lds
    v_bfe_u32 v13, v0, 2, 2
    v_and_b32 v14, 3, v0
    v_lshlrev_b32 v14, 3, v14
    v_lshl_add_u32 v14, v13, 7, v14
    s_mul_i32 s10, s8, 28672
    v_add_u32 v144, s10, v14
    v_lshrrev_b32 v13, 1, v13
    s_lshl_b32 s10, s8, 1
    v_xor_b32 v13, s10, v13
    v_mfma_f32_32x32x16_bf16 v[160:175], v[140:143], v[28:31], v[160:175]
    ds_read_b128 v[40:43], v8 offset:16384
    ds_read_b64_tr_b16 v[136:137], v10 offset:20480
    ds_read_b64_tr_b16 v[138:139], v10 offset:20992
    ds_read_b128 v[44:47], v9 offset:16384
    ds_read_b64_tr_b16 v[140:141], v10 offset:22528
    ds_read_b64_tr_b16 v[142:143], v10 offset:23040
    s_add_u32 m0, s15, 0
    s_nop 0
    buffer_load_dwordx4 v1, s[40:43], s79 offen lds
    v_bfe_u32 v14, v0, 4, 1
    v_lshlrev_b32 v14, 1, v14
    v_xor_b32 v13, v14, v13
    v_lshlrev_b32 v145, 5, v13
    v_and_b32 v13, 15, v0
    s_and_b32 s10, s7, 1
    s_lshl_b32 s10, s10, 4
    v_add_u32 v146, s10, v13
    s_waitcnt lgkmcnt(9)
    v_mfma_f32_32x32x16_bf16 v[160:175], v[128:131], v[32:35], v[160:175]
    s_add_u32 m0, s15, 1024
    s_nop 0
    buffer_load_dwordx4 v2, s[40:43], s79 offen lds
    s_mul_i32 s10, s95, 7
    s_add_u32 s10, s10, s96
    s_lshl_b32 s10, s10, 7
    s_add_u32 s10, s10, 32768
    v_mov_b32 v147, s10
    s_waitcnt lgkmcnt(6)
    v_mfma_f32_32x32x16_bf16 v[160:175], v[132:135], v[36:39], v[160:175]
    s_add_u32 m0, s99, 49152
    s_nop 0
    buffer_load_dwordx4 v3, s[72:75], s86 offen lds
    s_waitcnt lgkmcnt(0)
    s_waitcnt vmcnt(4)
    s_barrier
    v_mfma_f32_32x32x16_bf16 v[160:175], v[136:139], v[40:43], v[160:175]
    ds_read_b128 v[48:51], v6 offset:32768
    ds_read_b64_tr_b16 v[128:129], v10 offset:32768
    ds_read_b64_tr_b16 v[130:131], v10 offset:33280
    ds_read_b128 v[52:55], v7 offset:32768
    ds_read_b64_tr_b16 v[132:133], v10 offset:34816
    ds_read_b64_tr_b16 v[134:135], v10 offset:35328
    s_add_u32 m0, s14, 121984
    s_nop 0
    buffer_load_dwordx4 v3, s[72:75], s85 offen offset:896 lds
    v_and_b32 v148, 15, v0
    s_lshl_b32 s10, s95, 6
    s_lshl_b32 s11, s7, 4
    s_add_u32 s10, s10, s11
    v_add_u32 v148, s10, v148
    v_mul_u32_u24 v148, 896, v148
    v_bfe_u32 v13, v0, 4, 1
    v_lshl_add_u32 v148, v13, 5, v148
    v_mfma_f32_32x32x16_bf16 v[160:175], v[140:143], v[44:47], v[160:175]
    ds_read_b128 v[56:59], v8 offset:32768
    ds_read_b64_tr_b16 v[136:137], v10 offset:36864
    ds_read_b64_tr_b16 v[138:139], v10 offset:37376
    ds_read_b128 v[60:63], v9 offset:32768
    ds_read_b64_tr_b16 v[140:141], v10 offset:38912
    ds_read_b64_tr_b16 v[142:143], v10 offset:39424
    ds_read_u16 v152, v193
    s_add_u32 m0, s15, 16384
    s_nop 0
    buffer_load_dwordx4 v1, s[40:43], s80 offen lds
    v_lshrrev_b32 v13, 5, v0
    v_lshl_add_u32 v148, v13, 4, v148
    s_lshl_b32 s10, s96, 7
    s_lshl_b32 s11, s8, 6
    s_add_u32 s10, s10, s11
    v_add_u32 v148, s10, v148
    s_lshl_b32 s10, s7, 12
    s_lshl_b32 s11, s8, 11
    s_add_u32 s1, s10, s11
    s_add_u32 s10, s1, 49152
    v_add_u32 v252, s10, v12
    s_waitcnt lgkmcnt(10)
    v_mfma_f32_32x32x16_bf16 v[160:175], v[128:131], v[48:51], v[160:175]
    s_add_u32 m0, s15, 17408
    s_nop 0
    buffer_load_dwordx4 v2, s[40:43], s80 offen lds
    v_lshrrev_b32 v13, 5, v0
    s_lshl_b32 s11, s8, 11
    v_mul_u32_u24 v13, s11, v13
    s_waitcnt lgkmcnt(7)
    v_mfma_f32_32x32x16_bf16 v[160:175], v[132:135], v[52:55], v[160:175]
    s_add_u32 m0, s99, 65536
    s_nop 0
    buffer_load_dwordx4 v3, s[72:75], s87 offen lds
    s_waitcnt lgkmcnt(1)
    s_waitcnt vmcnt(4)
    s_barrier
    v_mfma_f32_32x32x16_bf16 v[160:175], v[136:139], v[56:59], v[160:175]
    ds_read_b128 v[64:67], v6 offset:0
    ds_read_b64_tr_b16 v[128:129], v10 offset:0
    ds_read_b64_tr_b16 v[130:131], v10 offset:512
    ds_read_b128 v[68:71], v7 offset:0
    ds_read_b64_tr_b16 v[132:133], v10 offset:2048
    ds_read_b64_tr_b16 v[134:135], v10 offset:2560
    s_add_u32 m0, s14, 130176
    s_nop 0
    buffer_load_dwordx4 v3, s[72:75], s86 offen offset:896 lds
    v_sub_u32 v253, v252, v13
    v_add_u32 v253, 1024, v253
    v_and_b32 v13, 31, v0
    s_mul_i32 s10, s8, 28
    v_add_u32 v14, s10, v13
    s_lshl_b32 s10, s8, 5
    v_or_b32 v13, s10, v13
    v_mfma_f32_32x32x16_bf16 v[160:175], v[140:143], v[60:63], v[160:175]
    ds_read_b128 v[72:75], v8 offset:0
    ds_read_b64_tr_b16 v[136:137], v10 offset:4096
    ds_read_b64_tr_b16 v[138:139], v10 offset:4608
    ds_read_b128 v[76:79], v9 offset:0
    ds_read_b64_tr_b16 v[140:141], v10 offset:6144
    ds_read_b64_tr_b16 v[142:143], v10 offset:6656
    s_add_u32 m0, s15, 32768
    s_nop 0
    buffer_load_dwordx4 v1, s[40:43], s81 offen lds
    v_cmp_eq_u32 vcc, 28, v13
    s_nop 1
    v_cndmask_b32 v14, v14, 60, vcc
    v_lshrrev_b32 v13, 5, v0
    v_lshl_add_u32 v14, v13, 6, v14
    s_lshl_b32 s10, s7, 12
    s_add_u32 s10, s10, 0
    v_lshl_add_u32 v251, v14, 4, s10
    s_waitcnt lgkmcnt(9)
    v_mfma_f32_32x32x16_bf16 v[160:175], v[128:131], v[64:67], v[160:175]
    s_add_u32 m0, s15, 33792
    s_nop 0
    buffer_load_dwordx4 v2, s[40:43], s81 offen lds
    s_sub_u32 s0, s8, 1
    v_or_b32 v250, s0, v11
    s_not_b32 s10, s0
    v_or_b32 v249, s10, v11
    v_min_u32 v13, 11, v0
    v_lshrrev_b32 v14, 2, v13
    s_waitcnt lgkmcnt(6)
    v_mfma_f32_32x32x16_bf16 v[160:175], v[132:135], v[68:71], v[160:175]
    s_add_u32 m0, s99, 81920
    s_nop 0
    buffer_load_dwordx4 v3, s[72:75], s88 offen lds
    s_waitcnt lgkmcnt(0)
    s_branch L_pg_b_1_go
.p2align 12
L_pg_b_1_go:
    s_waitcnt vmcnt(4)
    s_barrier
    v_mfma_f32_32x32x16_bf16 v[160:175], v[136:139], v[72:75], v[160:175]
    ds_read_b128 v[80:83], v6 offset:16384
    ds_read_b64_tr_b16 v[128:129], v10 offset:16384
    ds_read_b64_tr_b16 v[130:131], v10 offset:16896
    ds_read_b128 v[84:87], v7 offset:16384
    ds_read_b64_tr_b16 v[132:133], v10 offset:18432
    ds_read_b64_tr_b16 v[134:135], v10 offset:18944
    s_add_u32 m0, s14, 138368
    s_nop 0
    buffer_load_dwordx4 v3, s[72:75], s87 offen offset:896 lds
    v_cmp_ge_u32 vcc, s6, v14
    v_mov_b32 v15, s92
    s_nop 0
    v_cndmask_b32 v156, 0, v15, vcc
    v_mov_b32 v157, v156
    v_mov_b32 v158, v156
    v_mov_b32 v159, v156
    v_sub_u32 v14, 2, v14
    v_mfma_f32_32x32x16_bf16 v[160:175], v[140:143], v[76:79], v[160:175]
    ds_read_b128 v[88:91], v8 offset:16384
    ds_read_b64_tr_b16 v[136:137], v10 offset:20480
    ds_read_b64_tr_b16 v[138:139], v10 offset:20992
    ds_read_b128 v[92:95], v9 offset:16384
    ds_read_b64_tr_b16 v[140:141], v10 offset:22528
    ds_read_b64_tr_b16 v[142:143], v10 offset:23040
    s_add_u32 m0, s15, 0
    s_nop 0
    buffer_load_dwordx4 v1, s[40:43], s82 offen lds
    v_lshlrev_b32 v14, 14, v14
    v_bfe_u32 v15, v13, 1, 1
    v_lshl_add_u32 v14, v15, 10, v14
    v_and_b32 v15, 1, v13
    v_lshl_add_u32 v14, v15, 6, v14
    v_add_u32 v248, s1, v14
    s_mul_i32 s92, s5, 3584
    s_add_u32 s92, s92, s39
    s_lshl_b32 s10, s8, 11
    s_add_u32 s92, s92, s10
    s_waitcnt lgkmcnt(9)
    v_mfma_f32_32x32x16_bf16 v[160:175], v[128:131], v[80:83], v[160:175]
    s_add_u32 m0, s15, 1024
    s_nop 0
    buffer_load_dwordx4 v2, s[40:43], s82 offen lds
    s_mul_i32 s97, s5, 896
    s_add_u32 s97, s97, s39
    s_mul_i32 s10, s8, 14336
    s_add_u32 s97, s97, s10
    s_waitcnt lgkmcnt(6)
    v_mfma_f32_32x32x16_bf16 v[160:175], v[132:135], v[84:87], v[160:175]
    s_add_u32 m0, s99, 49152
    s_nop 0
    buffer_load_dwordx4 v3, s[72:75], s89 offen lds
    s_waitcnt lgkmcnt(0)
    s_waitcnt vmcnt(4)
    s_barrier
    v_mfma_f32_32x32x16_bf16 v[160:175], v[136:139], v[88:91], v[160:175]
    ds_read_b128 v[96:99], v6 offset:32768
    ds_read_b64_tr_b16 v[128:129], v10 offset:32768
    ds_read_b64_tr_b16 v[130:131], v10 offset:33280
    ds_read_b128 v[100:103], v7 offset:32768
    ds_read_b64_tr_b16 v[132:133], v10 offset:34816
    ds_read_b64_tr_b16 v[134:135], v10 offset:35328
    s_lshl2_add_u32 s10, s6, s7
    s_lshl_b32 s10, s10, 5
    s_lshr_b32 s11, s93, 4
    s_lshl1_add_u32 s11, s11, s8
    s_add_u32 s10, s10, s11
    s_mul_i32 s10, s10, 2048
    s_add_u32 s93, s10, 6291456
    v_mov_b32 v255, 1
    v_lshlrev_b32 v193, 7, v0
    s_mov_b32 s40, s48
    s_mov_b32 s41, s49
    s_cmp_eq_u32 s3, 0
    s_cselect_b32 s42, 81920, 0
    v_mov_b32 v153, 0
    v_mov_b32 v154, v152
    v_mov_b32 v155, 0
    v_lshrrev_b32 v13, 3, v0
    v_mfma_f32_32x32x16_bf16 v[160:175], v[140:143], v[92:95], v[160:175]
    ds_read_b128 v[104:107], v8 offset:32768
    ds_read_b64_tr_b16 v[136:137], v10 offset:36864
    ds_read_b64_tr_b16 v[138:139], v10 offset:37376
    ds_read_b128 v[108:111], v9 offset:32768
    ds_read_b64_tr_b16 v[140:141], v10 offset:38912
    ds_read_b64_tr_b16 v[142:143], v10 offset:39424
    s_add_u32 m0, s14, 146560
    s_nop 0
    buffer_load_dwordx4 v3, s[72:75], s88 offen offset:896 lds
    v_and_b32 v14, 7, v0
    v_bfe_u32 v15, v0, 4, 2
    v_lshlrev_b32 v15, 1, v15
    v_xor_b32 v14, v15, v14
    s_lshl_b32 s10, s3, 3
    v_add_u32 v1, s10, v13
    v_mul_u32_u24 v1, 896, v1
    v_lshl_add_u32 v1, v14, 4, v1
    s_lshl_b32 s10, s96, 7
    v_add_u32 v1, s10, v1
    s_add_u32 s98, s14, 106496
    s_add_u32 s99, s14, 49152
    s_and_b32 s76, s95, 3
    s_lshl_b32 s76, s76, 14
    s_add_u32 s77, s76, 8192
    s_cmp_eq_u32 s77, 57344
    s_cselect_b32 s77, 0, s77
    s_waitcnt lgkmcnt(9)
    v_mfma_f32_32x32x16_bf16 v[160:175], v[128:131], v[96:99], v[160:175]
    s_add_u32 m0, s14, 154752
    s_nop 0
    buffer_load_dwordx4 v3, s[72:75], s89 offen offset:896 lds
    s_add_u32 s78, s77, 8192
    s_cmp_eq_u32 s78, 57344
    s_cselect_b32 s78, 0, s78
    s_add_u32 s79, s78, 8192
    s_cmp_eq_u32 s79, 57344
    s_cselect_b32 s79, 0, s79
    s_add_u32 s80, s79, 8192
    s_cmp_eq_u32 s80, 57344
    s_cselect_b32 s80, 0, s80
    s_add_u32 s81, s80, 8192
    s_cmp_eq_u32 s81, 57344
    s_cselect_b32 s81, 0, s81
    s_add_u32 s82, s81, 8192
    s_cmp_eq_u32 s82, 57344
    s_cselect_b32 s82, 0, s82
    v_mov_b32 v2, v148
    s_waitcnt lgkmcnt(6)
    v_mfma_f32_32x32x16_bf16 v[160:175], v[132:135], v[100:103], v[160:175]
    s_waitcnt lgkmcnt(0)
    s_waitcnt vmcnt(2)
    s_barrier
    v_mfma_f32_32x32x16_bf16 v[160:175], v[136:139], v[104:107], v[160:175]
    ds_read_b128 v[112:115], v6 offset:0
    ds_read_b64_tr_b16 v[128:129], v10 offset:0
    ds_read_b64_tr_b16 v[130:131], v10 offset:512
    ds_read_b128 v[116:119], v7 offset:0
    ds_read_b64_tr_b16 v[132:133], v10 offset:2048
    ds_read_b64_tr_b16 v[134:135], v10 offset:2560
    s_add_u32 m0, s14, 16384
    s_mov_b64 exec, s[90:91]
    buffer_load_dwordx4 v5, s[44:47], s83 offen lds
    s_mov_b64 exec, -1
    v_mfma_f32_32x32x16_bf16 v[160:175], v[140:143], v[108:111], v[160:175]
    ds_read_b128 v[120:123], v8 offset:0
    ds_read_b64_tr_b16 v[136:137], v10 offset:4096
    ds_read_b64_tr_b16 v[138:139], v10 offset:4608
    ds_read_b128 v[124:127], v9 offset:0
    ds_read_b64_tr_b16 v[140:141], v10 offset:6144
    ds_read_b64_tr_b16 v[142:143], v10 offset:6656
    s_add_u32 m0, s14, 24576
    s_mov_b64 exec, s[90:91]
    buffer_load_dwordx4 v5, s[44:47], s84 offen lds
    s_mov_b64 exec, -1
    s_waitcnt lgkmcnt(9)
    v_mfma_f32_32x32x16_bf16 v[160:175], v[128:131], v[112:115], v[160:175]
    buffer_load_dword v254, v198, s[68:71], 0 offen sc1
    s_waitcnt lgkmcnt(6)
    v_mfma_f32_32x32x16_bf16 v[160:175], v[132:135], v[116:119], v[160:175]
    s_waitcnt lgkmcnt(0)
    s_waitcnt vmcnt(4)
    s_setprio 1
    s_barrier
    v_mfma_f32_32x32x16_bf16 v[160:175], v[136:139], v[120:123], v[160:175]
    ds_read_b64_tr_b16 v[128:129], v4 offset:0
    ds_read_b64_tr_b16 v[130:131], v4 offset:512
    ds_read_b64_tr_b16 v[132:133], v4 offset:2048
    ds_read_b64_tr_b16 v[134:135], v4 offset:2560
    v_mfma_f32_32x32x16_bf16 v[160:175], v[140:143], v[124:127], v[160:175]
    ds_read_b64_tr_b16 v[136:137], v4 offset:4096
    ds_read_b64_tr_b16 v[138:139], v4 offset:4608
    ds_read_b64_tr_b16 v[140:141], v4 offset:6144
    ds_read_b64_tr_b16 v[142:143], v4 offset:6656
    s_waitcnt lgkmcnt(6)
    v_mfma_f32_32x32x16_bf16 v[176:191], v[16:19], v[128:131], 0
    s_nop 5
    v_cvt_pk_bf16_f32 v200, v160, v161
    v_cvt_pk_bf16_f32 v201, v162, v163
    v_cvt_pk_bf16_f32 v202, v164, v165
    v_cvt_pk_bf16_f32 v203, v166, v167
    v_cvt_pk_bf16_f32 v204, v168, v169
    v_cvt_pk_bf16_f32 v205, v170, v171
    v_cvt_pk_bf16_f32 v206, v172, v173
    v_cvt_pk_bf16_f32 v207, v174, v175
    s_waitcnt lgkmcnt(4)
    v_mfma_f32_32x32x16_bf16 v[176:191], v[20:23], v[132:135], v[176:191]
    s_lshl1_add_u32 s10, s5, s8
    s_lshl_b32 s10, s10, 11
    s_add_u32 s10, s10, s39
    s_add_u32 s10, s10, 1048576
    buffer_store_dwordx4 v[200:203], v12, s[48:51], s10 offen offset:0 sc1
    s_waitcnt lgkmcnt(0)
    v_mfma_f32_32x32x16_bf16 v[176:191], v[24:27], v[136:139], v[176:191]
    ds_read_b64_tr_b16 v[128:129], v4 offset:8192
    ds_read_b64_tr_b16 v[130:131], v4 offset:8704
    ds_read_b64_tr_b16 v[132:133], v4 offset:10240
    ds_read_b64_tr_b16 v[134:135], v4 offset:10752
    s_lshl1_add_u32 s10, s5, s8
    s_lshl_b32 s10, s10, 11
    s_add_u32 s10, s10, s39
    s_add_u32 s10, s10, 1048576
    buffer_store_dwordx4 v[204:207], v12, s[48:51], s10 offen offset:1024 sc1
    v_mfma_f32_32x32x16_bf16 v[176:191], v[28:31], v[140:143], v[176:191]
    ds_read_b64_tr_b16 v[136:137], v4 offset:12288
    ds_read_b64_tr_b16 v[138:139], v4 offset:12800
    ds_read_b64_tr_b16 v[140:141], v4 offset:14336
    ds_read_b64_tr_b16 v[142:143], v4 offset:14848
    s_waitcnt lgkmcnt(6)
    v_mfma_f32_32x32x16_bf16 v[176:191], v[32:35], v[128:131], v[176:191]
    s_setprio 0
    s_add_u32 m0, s14, 32768
    s_mov_b64 exec, s[90:91]
    buffer_load_dwordx4 v5, s[44:47], s85 offen lds
    s_mov_b64 exec, -1
    s_waitcnt lgkmcnt(4)
    v_mfma_f32_32x32x16_bf16 v[176:191], v[36:39], v[132:135], v[176:191]
    s_waitcnt lgkmcnt(0)
    v_mfma_f32_32x32x16_bf16 v[176:191], v[40:43], v[136:139], v[176:191]
    ds_read_b64_tr_b16 v[128:129], v4 offset:16384
    ds_read_b64_tr_b16 v[130:131], v4 offset:16896
    ds_read_b64_tr_b16 v[132:133], v4 offset:18432
    ds_read_b64_tr_b16 v[134:135], v4 offset:18944
    v_mfma_f32_32x32x16_bf16 v[176:191], v[44:47], v[140:143], v[176:191]
    ds_read_b64_tr_b16 v[136:137], v4 offset:20480
    ds_read_b64_tr_b16 v[138:139], v4 offset:20992
    ds_read_b64_tr_b16 v[140:141], v4 offset:22528
    ds_read_b64_tr_b16 v[142:143], v4 offset:23040
    s_waitcnt lgkmcnt(6)
    v_mfma_f32_32x32x16_bf16 v[176:191], v[48:51], v[128:131], v[176:191]
    s_add_u32 m0, s14, 40960
    s_mov_b64 exec, s[90:91]
    buffer_load_dwordx4 v5, s[44:47], s86 offen lds
    s_mov_b64 exec, -1
    s_waitcnt lgkmcnt(4)
    v_mfma_f32_32x32x16_bf16 v[176:191], v[52:55], v[132:135], v[176:191]
    ds_write_b128 v199, v[152:155]
    s_waitcnt lgkmcnt(1)
    v_mfma_f32_32x32x16_bf16 v[176:191], v[56:59], v[136:139], v[176:191]
    ds_read_b64_tr_b16 v[128:129], v4 offset:24576
    ds_read_b64_tr_b16 v[130:131], v4 offset:25088
    ds_read_b64_tr_b16 v[132:133], v4 offset:26624
    ds_read_b64_tr_b16 v[134:135], v4 offset:27136
    s_mov_b32 s32, s48
    s_mov_b32 s33, s49
    s_cmp_ge_u32 s6, 1
    s_cselect_b32 s34, 10485760, 0
    s_mov_b32 s52, s48
    s_mov_b32 s53, s49
    s_cmp_ge_u32 s6, 2
    s_cselect_b32 s54, 10485760, 0
    v_mfma_f32_32x32x16_bf16 v[176:191], v[60:63], v[140:143], v[176:191]
    ds_read_b64_tr_b16 v[136:137], v4 offset:28672
    ds_read_b64_tr_b16 v[138:139], v4 offset:29184
    ds_read_b64_tr_b16 v[140:141], v4 offset:30720
    ds_read_b64_tr_b16 v[142:143], v4 offset:31232
    v_mov_b32 v6, v144
    v_mov_b32 v7, v145
    s_waitcnt lgkmcnt(6)
    v_mfma_f32_32x32x16_bf16 v[176:191], v[64:67], v[128:131], v[176:191]
    v_mov_b32 v8, v146
    v_mov_b32 v9, v147
    s_mov_b32 s72, s48
    s_mov_b32 s73, s49
    s_mov_b32 s74, 10485760
    s_waitcnt lgkmcnt(4)
    v_mfma_f32_32x32x16_bf16 v[176:191], v[68:71], v[132:135], v[176:191]
    s_waitcnt lgkmcnt(0)
    v_mfma_f32_32x32x16_bf16 v[176:191], v[72:75], v[136:139], v[176:191]
    ds_read_b64_tr_b16 v[128:129], v4 offset:32768
    ds_read_b64_tr_b16 v[130:131], v4 offset:33280
    ds_read_b64_tr_b16 v[132:133], v4 offset:34816
    ds_read_b64_tr_b16 v[134:135], v4 offset:35328
    v_mfma_f32_32x32x16_bf16 v[176:191], v[76:79], v[140:143], v[176:191]
    ds_read_b64_tr_b16 v[136:137], v4 offset:36864
    ds_read_b64_tr_b16 v[138:139], v4 offset:37376
    ds_read_b64_tr_b16 v[140:141], v4 offset:38912
    ds_read_b64_tr_b16 v[142:143], v4 offset:39424
    s_waitcnt lgkmcnt(6)
    v_mfma_f32_32x32x16_bf16 v[176:191], v[80:83], v[128:131], v[176:191]
    s_waitcnt vmcnt(4)
    v_cmp_gt_u32 vcc, 1, v254
    s_nop 0
    s_cbranch_vccnz L_r_11
L_r_11b:
    v_mov_b32 v198, v194
    s_mov_b32 s68, s48
    s_mov_b32 s69, s49
    s_cmp_eq_u32 s3, 1
    s_cselect_b32 s70, 81920, 0
    s_cselect_b32 s9, 0, 64
    s_waitcnt lgkmcnt(4)
    v_mfma_f32_32x32x16_bf16 v[176:191], v[84:87], v[132:135], v[176:191]
    s_waitcnt lgkmcnt(0)
    v_mfma_f32_32x32x16_bf16 v[176:191], v[88:91], v[136:139], v[176:191]
    ds_read_b64_tr_b16 v[128:129], v4 offset:40960
    ds_read_b64_tr_b16 v[130:131], v4 offset:41472
    ds_read_b64_tr_b16 v[132:133], v4 offset:43008
    ds_read_b64_tr_b16 v[134:135], v4 offset:43520
    v_mfma_f32_32x32x16_bf16 v[176:191], v[92:95], v[140:143], v[176:191]
    ds_read_b64_tr_b16 v[136:137], v4 offset:45056
    ds_read_b64_tr_b16 v[138:139], v4 offset:45568
    ds_read_b64_tr_b16 v[140:141], v4 offset:47104
    ds_read_b64_tr_b16 v[142:143], v4 offset:47616
    s_waitcnt lgkmcnt(6)
    v_mfma_f32_32x32x16_bf16 v[176:191], v[96:99], v[128:131], v[176:191]
    s_add_u32 m0, s14, 0
    s_mov_b64 exec, s[90:91]
    buffer_load_dwordx4 v5, s[44:47], s87 offen lds
    s_mov_b64 exec, -1
    s_waitcnt lgkmcnt(4)
    v_mfma_f32_32x32x16_bf16 v[176:191], v[100:103], v[132:135], v[176:191]
    s_waitcnt lgkmcnt(0)
    s_waitcnt vmcnt(3)
    s_barrier
    v_mfma_f32_32x32x16_bf16 v[176:191], v[104:107], v[136:139], v[176:191]
    ds_read_b64_tr_b16 v[128:129], v4 offset:49152
    ds_read_b64_tr_b16 v[130:131], v4 offset:49664
    ds_read_b64_tr_b16 v[132:133], v4 offset:51200
    ds_read_b64_tr_b16 v[134:135], v4 offset:51712
    s_add_u32 s10, s38, 0
    s_mov_b64 exec, 1
    buffer_store_dword v255, off, s[40:43], s10 sc1
    s_mov_b64 exec, -1
    v_mfma_f32_32x32x16_bf16 v[176:191], v[108:111], v[140:143], v[176:191]
    ds_read_b64_tr_b16 v[136:137], v4 offset:53248
    ds_read_b64_tr_b16 v[138:139], v4 offset:53760
    ds_read_b64_tr_b16 v[140:141], v4 offset:55296
    ds_read_b64_tr_b16 v[142:143], v4 offset:55808
    s_add_u32 m0, s14, 8192
    s_mov_b64 exec, s[90:91]
    buffer_load_dwordx4 v5, s[44:47], s88 offen lds
    s_mov_b64 exec, -1
    s_waitcnt lgkmcnt(6)
    v_mfma_f32_32x32x16_bf16 v[176:191], v[112:115], v[128:131], v[176:191]
    s_add_u32 m0, s14, 98304
    s_mov_b64 exec, s[90:91]
    buffer_load_dwordx4 v5, s[44:47], s89 offen lds
    s_mov_b64 exec, -1
    s_waitcnt lgkmcnt(4)
    v_mfma_f32_32x32x16_bf16 v[176:191], v[116:119], v[132:135], v[176:191]
    s_waitcnt lgkmcnt(0)
    v_mfma_f32_32x32x16_bf16 v[176:191], v[120:123], v[136:139], v[176:191]
    v_mfma_f32_32x32x16_bf16 v[176:191], v[124:127], v[140:143], v[176:191]
L_qphase:
    s_waitcnt vmcnt(3)
    s_setprio 1
    s_barrier
    ds_read_b64_tr_b16 v[128:129], v196 offset:16384
    ds_read_b64_tr_b16 v[130:131], v196 offset:16896
    ds_read_b64_tr_b16 v[132:133], v196 offset:18432
    ds_read_b64_tr_b16 v[134:135], v196 offset:18944
    s_nop 4
    v_cvt_pk_bf16_f32 v240, v176, v177
    v_cvt_pk_bf16_f32 v241, v178, v179
    v_cvt_pk_bf16_f32 v242, v180, v181
    v_cvt_pk_bf16_f32 v243, v182, v183
    ds_read_b64_tr_b16 v[136:137], v196 offset:20480
    ds_read_b64_tr_b16 v[138:139], v196 offset:20992
    ds_read_b64_tr_b16 v[140:141], v196 offset:22528
    ds_read_b64_tr_b16 v[142:143], v196 offset:23040
    v_cvt_pk_bf16_f32 v244, v184, v185
    v_cvt_pk_bf16_f32 v245, v186, v187
    v_cvt_pk_bf16_f32 v246, v188, v189
    v_cvt_pk_bf16_f32 v247, v190, v191
    s_waitcnt lgkmcnt(6)
    v_mfma_f32_32x32x16_bf16 v[160:175], v[128:131], v[16:19], 0
    s_lshl1_add_u32 s10, s5, s8
    s_lshl_b32 s10, s10, 9
    s_add_u32 s10, s10, s39
    s_add_u32 s10, s10, 3145728
    buffer_store_dwordx4 v[240:243], v197, s[72:75], s10 offen sc1
    s_waitcnt lgkmcnt(4)
    v_mfma_f32_32x32x16_bf16 v[160:175], v[132:135], v[20:23], v[160:175]
    s_lshl1_add_u32 s10, s5, s8
    s_lshl_b32 s10, s10, 9
    s_add_u32 s10, s10, s39
    s_add_u32 s10, s10, 3160064
    buffer_store_dwordx4 v[244:247], v197, s[72:75], s10 offen sc1
    s_setprio 0
    s_waitcnt lgkmcnt(0)
    v_mfma_f32_32x32x16_bf16 v[160:175], v[136:139], v[24:27], v[160:175]
    ds_read_b64_tr_b16 v[128:129], v196 offset:24576
    ds_read_b64_tr_b16 v[130:131], v196 offset:25088
    ds_read_b64_tr_b16 v[132:133], v196 offset:26624
    ds_read_b64_tr_b16 v[134:135], v196 offset:27136
    v_mfma_f32_32x32x16_bf16 v[160:175], v[140:143], v[28:31], v[160:175]
    ds_read_b64_tr_b16 v[136:137], v196 offset:28672
    ds_read_b64_tr_b16 v[138:139], v196 offset:29184
    ds_read_b64_tr_b16 v[140:141], v196 offset:30720
    ds_read_b64_tr_b16 v[142:143], v196 offset:31232
    s_waitcnt lgkmcnt(6)
    v_mfma_f32_32x32x16_bf16 v[160:175], v[128:131], v[32:35], v[160:175]
    s_waitcnt lgkmcnt(4)
    v_mfma_f32_32x32x16_bf16 v[160:175], v[132:135], v[36:39], v[160:175]
    s_waitcnt lgkmcnt(0)
    v_mfma_f32_32x32x16_bf16 v[160:175], v[136:139], v[40:43], v[160:175]
    ds_read_b64_tr_b16 v[128:129], v196 offset:32768
    ds_read_b64_tr_b16 v[130:131], v196 offset:33280
    ds_read_b64_tr_b16 v[132:133], v196 offset:34816
    ds_read_b64_tr_b16 v[134:135], v196 offset:35328
    v_mfma_f32_32x32x16_bf16 v[160:175], v[140:143], v[44:47], v[160:175]
    ds_read_b64_tr_b16 v[136:137], v196 offset:36864
    ds_read_b64_tr_b16 v[138:139], v196 offset:37376
    ds_read_b64_tr_b16 v[140:141], v196 offset:38912
    ds_read_b64_tr_b16 v[142:143], v196 offset:39424
    s_waitcnt lgkmcnt(6)
    v_mfma_f32_32x32x16_bf16 v[160:175], v[128:131], v[48:51], v[160:175]
    s_waitcnt lgkmcnt(4)
    v_mfma_f32_32x32x16_bf16 v[160:175], v[132:135], v[52:55], v[160:175]
    s_waitcnt lgkmcnt(0)
    v_mfma_f32_32x32x16_bf16 v[160:175], v[136:139], v[56:59], v[160:175]
    ds_read_b64_tr_b16 v[128:129], v196 offset:40960
    ds_read_b64_tr_b16 v[130:131], v196 offset:41472
    ds_read_b64_tr_b16 v[132:133], v196 offset:43008
    ds_read_b64_tr_b16 v[134:135], v196 offset:43520
    v_mfma_f32_32x32x16_bf16 v[160:175], v[140:143], v[60:63], v[160:175]
    ds_read_b64_tr_b16 v[136:137], v196 offset:45056
    ds_read_b64_tr_b16 v[138:139], v196 offset:45568
    ds_read_b64_tr_b16 v[140:141], v196 offset:47104
    ds_read_b64_tr_b16 v[142:143], v196 offset:47616
    s_waitcnt lgkmcnt(6)
    v_mfma_f32_32x32x16_bf16 v[160:175], v[128:131], v[64:67], v[160:175]
    s_waitcnt lgkmcnt(4)
    v_mfma_f32_32x32x16_bf16 v[160:175], v[132:135], v[68:71], v[160:175]
    v_mov_b32 v254, 64
    s_mov_b64 exec, 63
    v_mov_b32 v254, 0
    buffer_atomic_or v254, v198, s[68:71], 0 offen sc0 sc1
    s_mov_b64 exec, -1
    s_waitcnt lgkmcnt(0)
    v_mfma_f32_32x32x16_bf16 v[160:175], v[136:139], v[72:75], v[160:175]
    ds_read_b64_tr_b16 v[128:129], v196 offset:0
    ds_read_b64_tr_b16 v[130:131], v196 offset:512
    ds_read_b64_tr_b16 v[132:133], v196 offset:2048
    ds_read_b64_tr_b16 v[134:135], v196 offset:2560
    v_mfma_f32_32x32x16_bf16 v[160:175], v[140:143], v[76:79], v[160:175]
    ds_read_b64_tr_b16 v[136:137], v196 offset:4096
    ds_read_b64_tr_b16 v[138:139], v196 offset:4608
    ds_read_b64_tr_b16 v[140:141], v196 offset:6144
    ds_read_b64_tr_b16 v[142:143], v196 offset:6656
    s_waitcnt lgkmcnt(6)
    v_mfma_f32_32x32x16_bf16 v[160:175], v[128:131], v[80:83], v[160:175]
    s_waitcnt lgkmcnt(4)
    v_mfma_f32_32x32x16_bf16 v[160:175], v[132:135], v[84:87], v[160:175]
    s_waitcnt lgkmcnt(0)
    s_waitcnt vmcnt(0)
    v_or_b32 v254, s9, v254
    v_cmp_gt_u32 vcc, 1, v254
    s_nop 0
    s_cbranch_vccnz L_r_12
L_r_12b:
    s_barrier
    v_mfma_f32_32x32x16_bf16 v[160:175], v[136:139], v[88:91], v[160:175]
    ds_read_b64_tr_b16 v[128:129], v196 offset:8192
    ds_read_b64_tr_b16 v[130:131], v196 offset:8704
    ds_read_b64_tr_b16 v[132:133], v196 offset:10240
    ds_read_b64_tr_b16 v[134:135], v196 offset:10752
    s_add_u32 s10, s38, 49152
    s_mov_b64 exec, 1
    buffer_store_dword v255, off, s[40:43], s10 sc1
    s_mov_b64 exec, -1
    s_add_u32 m0, s1, 81920
    s_add_u32 s10, s92, 1048576
    buffer_load_dwordx4 v12, s[48:51], s10 offen sc1 lds
    s_mov_b32 exec_hi, s0
    buffer_load_dwordx4 v12, s[48:51], s10 offen offset:1024 sc1 lds
    s_mov_b32 exec_hi, -1
    v_mfma_f32_32x32x16_bf16 v[160:175], v[140:143], v[92:95], v[160:175]
    ds_read_b64_tr_b16 v[136:137], v196 offset:12288
    ds_read_b64_tr_b16 v[138:139], v196 offset:12800
    ds_read_b64_tr_b16 v[140:141], v196 offset:14336
    ds_read_b64_tr_b16 v[142:143], v196 offset:14848
    s_waitcnt lgkmcnt(6)
    v_mfma_f32_32x32x16_bf16 v[160:175], v[128:131], v[96:99], v[160:175]
    s_add_u32 m0, s1, 65536
    s_add_u32 s10, s92, 933888
    buffer_load_dwordx4 v12, s[32:35], s10 offen sc1 lds
    s_mov_b32 exec_hi, s0
    buffer_load_dwordx4 v12, s[32:35], s10 offen offset:1024 sc1 lds
    s_mov_b32 exec_hi, -1
    v_add_u32 v196, 49152, v196
    s_waitcnt lgkmcnt(4)
    v_mfma_f32_32x32x16_bf16 v[160:175], v[132:135], v[100:103], v[160:175]
    s_waitcnt lgkmcnt(0)
    v_mfma_f32_32x32x16_bf16 v[160:175], v[136:139], v[104:107], v[160:175]
    ds_read_b64_tr_b16 v[128:129], v196 offset:49152
    ds_read_b64_tr_b16 v[130:131], v196 offset:49664
    ds_read_b64_tr_b16 v[132:133], v196 offset:51200
    ds_read_b64_tr_b16 v[134:135], v196 offset:51712
    s_add_u32 m0, s1, 49152
    s_add_u32 s10, s92, 819200
    buffer_load_dwordx4 v12, s[52:55], s10 offen sc1 lds
    s_mov_b32 exec_hi, s0
    buffer_load_dwordx4 v12, s[52:55], s10 offen offset:1024 sc1 lds
    s_mov_b32 exec_hi, -1
    v_mfma_f32_32x32x16_bf16 v[160:175], v[140:143], v[108:111], v[160:175]
    ds_read_b64_tr_b16 v[136:137], v196 offset:53248
    ds_read_b64_tr_b16 v[138:139], v196 offset:53760
    ds_read_b64_tr_b16 v[140:141], v196 offset:55296
    ds_read_b64_tr_b16 v[142:143], v196 offset:55808
    s_waitcnt lgkmcnt(6)
    v_mfma_f32_32x32x16_bf16 v[160:175], v[128:131], v[112:115], v[160:175]
    s_waitcnt lgkmcnt(4)
    v_mfma_f32_32x32x16_bf16 v[160:175], v[132:135], v[116:119], v[160:175]
    s_waitcnt lgkmcnt(0)
    v_mfma_f32_32x32x16_bf16 v[160:175], v[136:139], v[120:123], v[160:175]
    v_mfma_f32_32x32x16_bf16 v[160:175], v[140:143], v[124:127], v[160:175]
    v_add_u32 v198, 49152, v198
    s_nop 10
    v_bfi_b32 v192, v250, v172, v168
    v_mul_f32 v192, 0x3fb8aa3b, v192
    v_mov_b32 v13, 0x3e8b97f6
    v_mul_f32 v160, v13, v160
    v_mul_f32 v161, v13, v161
    v_mul_f32 v162, v13, v162
    v_mul_f32 v163, v13, v163
    v_mul_f32 v164, v13, v164
    v_mul_f32 v165, v13, v165
    v_mul_f32 v166, v13, v166
    v_mul_f32 v167, v13, v167
    v_mul_f32 v168, v13, v168
    v_mul_f32 v169, v13, v169
    v_mul_f32 v170, v13, v170
    v_mul_f32 v171, v13, v171
    v_mul_f32 v172, v13, v172
    v_mul_f32 v173, v13, v173
    v_mul_f32 v174, v13, v174
    v_mul_f32 v175, v13, v175
    v_exp_f32 v192, v192
    v_cvt_pk_bf16_f32 v120, v160, v161
    v_cvt_pk_bf16_f32 v121, v162, v163
    v_cvt_pk_bf16_f32 v122, v164, v165
    v_cvt_pk_bf16_f32 v123, v166, v167
    v_cvt_pk_bf16_f32 v124, v168, v169
    v_cvt_pk_bf16_f32 v125, v170, v171
    v_cvt_pk_bf16_f32 v126, v172, v173
    v_cvt_pk_bf16_f32 v127, v174, v175
    v_and_b32 v124, v250, v124
    v_and_b32 v125, v250, v125
    v_and_b32 v126, v249, v126
    v_and_b32 v127, v249, v127
    v_add_f32 v192, 1.0, v192
    v_mov_b32 v254, 64
    s_mov_b64 exec, 63
    v_mov_b32 v254, 0
    buffer_atomic_or v254, v198, s[68:71], 0 offen sc0 sc1
    s_mov_b64 exec, -1
    s_add_u32 m0, s76, s98
    s_mul_i32 s13, s76, 7
    buffer_load_dwordx4 v1, s[60:63], s13 offen lds
    s_add_u32 m0, s77, s98
    s_mul_i32 s13, s77, 7
    buffer_load_dwordx4 v1, s[60:63], s13 offen lds
    s_add_u32 m0, s78, s98
    s_mul_i32 s13, s78, 7
    buffer_load_dwordx4 v1, s[60:63], s13 offen lds
    s_branch L_pg_b_2_go
.p2align 12
L_pg_b_2_go:
L_bpage:
    s_waitcnt vmcnt(6)
    s_barrier
    ds_read_b128 v[128:131], v252 offset:32768
    ds_read_b128 v[132:135], v253 offset:32768
    ds_read_b128 v[136:139], v252 offset:28672
    ds_read_b128 v[140:143], v253 offset:28672
    s_waitcnt lgkmcnt(2)
    v_mfma_f32_32x32x16_bf16 v[16:31], v[128:131], v[120:123], v[208:223]
    v_mfma_f32_32x32x16_bf16 v[16:31], v[132:135], v[124:127], v[16:31]
    s_mov_b64 exec, 0xfff
    ds_write_b128 v248, v[156:159] offset:896
    s_mov_b64 exec, -1
    s_setprio 3
    s_waitcnt lgkmcnt(1)
    v_mfma_f32_32x32x16_bf16 v[32:47], v[136:139], v[120:123], 0
    ds_read_b128 v[128:131], v252 offset:24576
    s_nop 4
    v_exp_f32 v16, v16
    v_exp_f32 v17, v17
    v_exp_f32 v18, v18
    v_exp_f32 v19, v19
    v_cvt_pk_bf16_f32 v48, v16, v17
    v_exp_f32 v20, v20
    v_exp_f32 v21, v21
    v_cvt_pk_bf16_f32 v49, v18, v19
    v_exp_f32 v22, v22
    v_exp_f32 v23, v23
    v_cvt_pk_bf16_f32 v50, v20, v21
    v_exp_f32 v24, v24
    v_exp_f32 v25, v25
    v_mfma_f32_32x32x16_bf16 v[32:47], v[140:143], v[124:127], v[32:47]
    ds_read_b128 v[132:135], v253 offset:24576
    v_cvt_pk_bf16_f32 v51, v22, v23
    v_exp_f32 v26, v26
    v_exp_f32 v27, v27
    v_cvt_pk_bf16_f32 v52, v24, v25
    v_exp_f32 v28, v28
    v_exp_f32 v29, v29
    v_cvt_pk_bf16_f32 v53, v26, v27
    v_exp_f32 v30, v30
    v_exp_f32 v31, v31
    v_cvt_pk_bf16_f32 v54, v28, v29
    v_cvt_pk_bf16_f32 v55, v30, v31
    s_waitcnt vmcnt(3)
    v_or_b32 v254, s9, v254
    v_cmp_gt_u32 vcc, 1, v254
    s_nop 0
    s_cbranch_vccnz L_r_13
L_r_13b:
    s_barrier
    s_setprio 3
    s_waitcnt lgkmcnt(0)
    v_mfma_f32_32x32x16_bf16 v[16:31], v[128:131], v[120:123], 0
    ds_read_b128 v[136:139], v252 offset:20480
    s_mov_b32 exec_hi, 0xffffff
    s_add_u32 m0, s1, 32768
    s_add_u32 s10, s97, 3145728
    buffer_load_dwordx4 v12, s[48:51], s10 offen sc1 lds
    s_add_u32 m0, s1, 33792
    s_add_u32 s10, s97, 3152896
    buffer_load_dwordx4 v12, s[48:51], s10 offen sc1 lds
    s_mov_b32 exec_hi, -1
    v_exp_f32 v32, v32
    v_exp_f32 v33, v33
    v_exp_f32 v34, v34
    v_exp_f32 v35, v35
    v_cvt_pk_bf16_f32 v56, v32, v33
    v_exp_f32 v36, v36
    v_exp_f32 v37, v37
    v_cvt_pk_bf16_f32 v57, v34, v35
    v_exp_f32 v38, v38
    v_exp_f32 v39, v39
    v_cvt_pk_bf16_f32 v58, v36, v37
    v_exp_f32 v40, v40
    v_exp_f32 v41, v41
    v_mfma_f32_32x32x16_bf16 v[16:31], v[132:135], v[124:127], v[16:31]
    ds_read_b128 v[140:143], v253 offset:20480
    s_mov_b32 exec_hi, 0xffffff
    s_add_u32 m0, s1, 16384
    s_add_u32 s10, s97, 3031040
    buffer_load_dwordx4 v12, s[32:35], s10 offen sc1 lds
    s_add_u32 m0, s1, 17408
    s_add_u32 s10, s97, 3038208
    buffer_load_dwordx4 v12, s[32:35], s10 offen sc1 lds
    s_mov_b32 exec_hi, -1
    v_cvt_pk_bf16_f32 v59, v38, v39
    v_exp_f32 v42, v42
    v_exp_f32 v43, v43
    v_cvt_pk_bf16_f32 v60, v40, v41
    v_exp_f32 v44, v44
    v_exp_f32 v45, v45
    v_cvt_pk_bf16_f32 v61, v42, v43
    v_exp_f32 v46, v46
    v_exp_f32 v47, v47
    v_cvt_pk_bf16_f32 v62, v44, v45
    v_cvt_pk_bf16_f32 v63, v46, v47
    s_setprio 2
    s_waitcnt lgkmcnt(0)
    v_mfma_f32_32x32x16_bf16 v[32:47], v[136:139], v[120:123], 0
    ds_read_b128 v[128:131], v252 offset:16384
    s_mov_b32 exec_hi, 0xffffff
    s_add_u32 m0, s1, 0
    s_add_u32 s10, s97, 2916352
    buffer_load_dwordx4 v12, s[52:55], s10 offen sc1 lds
    s_add_u32 m0, s1, 1024
    s_add_u32 s10, s97, 2923520
    buffer_load_dwordx4 v12, s[52:55], s10 offen sc1 lds
    s_mov_b32 exec_hi, -1
    v_exp_f32 v16, v16
    v_exp_f32 v17, v17
    v_exp_f32 v18, v18
    v_exp_f32 v19, v19
    v_cvt_pk_bf16_f32 v64, v16, v17
    v_exp_f32 v20, v20
    v_exp_f32 v21, v21
    v_cvt_pk_bf16_f32 v65, v18, v19
    v_exp_f32 v22, v22
    v_exp_f32 v23, v23
    v_cvt_pk_bf16_f32 v66, v20, v21
    v_exp_f32 v24, v24
    v_exp_f32 v25, v25
    v_mfma_f32_32x32x16_bf16 v[32:47], v[140:143], v[124:127], v[32:47]
    ds_read_b128 v[132:135], v253 offset:16384
    v_cvt_pk_bf16_f32 v67, v22, v23
    v_exp_f32 v26, v26
    v_exp_f32 v27, v27
    v_cvt_pk_bf16_f32 v68, v24, v25
    v_exp_f32 v28, v28
    v_exp_f32 v29, v29
    v_cvt_pk_bf16_f32 v69, v26, v27
    v_exp_f32 v30, v30
    v_exp_f32 v31, v31
    v_cvt_pk_bf16_f32 v70, v28, v29
    v_cvt_pk_bf16_f32 v71, v30, v31
    s_setprio 1
    s_waitcnt lgkmcnt(0)
    v_mfma_f32_32x32x16_bf16 v[16:31], v[128:131], v[120:123], 0
    ds_read_b128 v[136:139], v252 offset:12288
    s_add_u32 m0, s79, s98
    s_mul_i32 s13, s79, 7
    buffer_load_dwordx4 v1, s[60:63], s13 offen lds
    s_add_u32 m0, s80, s98
    s_mul_i32 s13, s80, 7
    buffer_load_dwordx4 v1, s[60:63], s13 offen lds
    v_exp_f32 v32, v32
    v_exp_f32 v33, v33
    v_exp_f32 v34, v34
    v_exp_f32 v35, v35
    v_cvt_pk_bf16_f32 v72, v32, v33
    v_exp_f32 v36, v36
    v_exp_f32 v37, v37
    v_cvt_pk_bf16_f32 v73, v34, v35
    v_exp_f32 v38, v38
    v_exp_f32 v39, v39
    v_cvt_pk_bf16_f32 v74, v36, v37
    v_exp_f32 v40, v40
    v_exp_f32 v41, v41
    v_mfma_f32_32x32x16_bf16 v[16:31], v[132:135], v[124:127], v[16:31]
    ds_read_b128 v[140:143], v253 offset:12288
    v_cvt_pk_bf16_f32 v75, v38, v39
    v_exp_f32 v42, v42
    v_exp_f32 v43, v43
    v_cvt_pk_bf16_f32 v76, v40, v41
    v_exp_f32 v44, v44
    v_exp_f32 v45, v45
    v_cvt_pk_bf16_f32 v77, v42, v43
    v_exp_f32 v46, v46
    v_exp_f32 v47, v47
    v_cvt_pk_bf16_f32 v78, v44, v45
    v_cvt_pk_bf16_f32 v79, v46, v47
    s_setprio 0
    s_waitcnt lgkmcnt(0)
    v_mfma_f32_32x32x16_bf16 v[32:47], v[136:139], v[120:123], 0
    ds_read_b128 v[128:131], v252 offset:8192
    s_add_u32 m0, s81, s98
    s_mul_i32 s13, s81, 7
    buffer_load_dwordx4 v1, s[60:63], s13 offen lds
    s_add_u32 m0, s82, s98
    s_mul_i32 s13, s82, 7
    buffer_load_dwordx4 v1, s[60:63], s13 offen lds
    v_exp_f32 v16, v16
    v_exp_f32 v17, v17
    v_exp_f32 v18, v18
    v_exp_f32 v19, v19
    v_cvt_pk_bf16_f32 v80, v16, v17
    v_exp_f32 v20, v20
    v_exp_f32 v21, v21
    v_cvt_pk_bf16_f32 v81, v18, v19
    v_exp_f32 v22, v22
    v_exp_f32 v23, v23
    v_cvt_pk_bf16_f32 v82, v20, v21
    v_exp_f32 v24, v24
    v_exp_f32 v25, v25
    v_mfma_f32_32x32x16_bf16 v[32:47], v[140:143], v[124:127], v[32:47]
    ds_read_b128 v[132:135], v253 offset:8192
    v_cvt_pk_bf16_f32 v83, v22, v23
    v_exp_f32 v26, v26
    v_exp_f32 v27, v27
    v_cvt_pk_bf16_f32 v84, v24, v25
    v_exp_f32 v28, v28
    v_exp_f32 v29, v29
    v_cvt_pk_bf16_f32 v85, v26, v27
    v_exp_f32 v30, v30
    v_exp_f32 v31, v31
    v_cvt_pk_bf16_f32 v86, v28, v29
    v_cvt_pk_bf16_f32 v87, v30, v31
    s_waitcnt vmcnt(4)
    s_barrier
    ds_read_b128 v[144:147], v251 offset:32768
    ds_read_b128 v[148:151], v251 offset:34816
    ds_read_b128 v[152:155], v251 offset:28672
    ds_read_b128 v[156:159], v251 offset:30720
    s_setprio 3
    s_waitcnt lgkmcnt(0)
    v_mfma_f32_32x32x16_bf16 v[16:31], v[128:131], v[120:123], 0
    ds_read_b128 v[136:139], v252 offset:4096
    s_add_u32 s13, s95, 0
    s_and_b32 s13, s13, 3
    s_add_u32 s13, s13, 3
    s_lshl_b32 s13, s13, 13
    s_add_u32 m0, s13, s99
    s_mul_i32 s13, s13, 7
    buffer_load_dwordx4 v1, s[64:67], s13 offen lds
    v_exp_f32 v32, v32
    v_exp_f32 v33, v33
    v_exp_f32 v34, v34
    v_exp_f32 v35, v35
    v_mfma_f32_32x32x16_bf16 v[16:31], v[132:135], v[124:127], v[16:31]
    ds_read_b128 v[140:143], v253 offset:4096
    v_cvt_pk_bf16_f32 v88, v32, v33
    v_exp_f32 v36, v36
    v_exp_f32 v37, v37
    v_cvt_pk_bf16_f32 v89, v34, v35
    v_mfma_f32_32x32x16_bf16 v[176:191], v[144:147], v[48:51], 0
    ds_read_b128 v[160:163], v251 offset:24576
    v_exp_f32 v38, v38
    v_exp_f32 v39, v39
    v_cvt_pk_bf16_f32 v90, v36, v37
    v_exp_f32 v40, v40
    v_exp_f32 v41, v41
    v_mfma_f32_32x32x16_bf16 v[176:191], v[148:151], v[52:55], v[176:191]
    ds_read_b128 v[164:167], v251 offset:26624
    v_cvt_pk_bf16_f32 v91, v38, v39
    v_exp_f32 v42, v42
    v_exp_f32 v43, v43
    v_mfma_f32_32x32x16_bf16 v[176:191], v[152:155], v[56:59], v[176:191]
    ds_read_b128 v[168:171], v251 offset:20480
    v_cvt_pk_bf16_f32 v92, v40, v41
    v_exp_f32 v44, v44
    v_exp_f32 v45, v45
    v_cvt_pk_bf16_f32 v93, v42, v43
    v_mfma_f32_32x32x16_bf16 v[176:191], v[156:159], v[60:63], v[176:191]
    ds_read_b128 v[172:175], v251 offset:22528
    v_exp_f32 v46, v46
    v_exp_f32 v47, v47
    v_cvt_pk_bf16_f32 v94, v44, v45
    v_cvt_pk_bf16_f32 v95, v46, v47
    s_setprio 2
    s_waitcnt lgkmcnt(0)
    v_mfma_f32_32x32x16_bf16 v[32:47], v[136:139], v[120:123], 0
    ds_read_b128 v[128:131], v252 offset:0
    v_exp_f32 v16, v16
    v_exp_f32 v17, v17
    v_exp_f32 v18, v18
    v_exp_f32 v19, v19
    v_mfma_f32_32x32x16_bf16 v[32:47], v[140:143], v[124:127], v[32:47]
    ds_read_b128 v[132:135], v253 offset:0
    v_cvt_pk_bf16_f32 v96, v16, v17
    v_exp_f32 v20, v20
    v_exp_f32 v21, v21
    v_cvt_pk_bf16_f32 v97, v18, v19
    v_mfma_f32_32x32x16_bf16 v[176:191], v[160:163], v[64:67], v[176:191]
    ds_read_b128 v[144:147], v251 offset:16384
    s_add_u32 s13, s95, 1
    s_and_b32 s13, s13, 3
    s_add_u32 s13, s13, 3
    s_lshl_b32 s13, s13, 13
    s_add_u32 m0, s13, s99
    s_mul_i32 s13, s13, 7
    buffer_load_dwordx4 v1, s[64:67], s13 offen lds
    v_exp_f32 v22, v22
    v_exp_f32 v23, v23
    v_cvt_pk_bf16_f32 v98, v20, v21
    v_exp_f32 v24, v24
    v_exp_f32 v25, v25
    v_mfma_f32_32x32x16_bf16 v[176:191], v[164:167], v[68:71], v[176:191]
    ds_read_b128 v[148:151], v251 offset:18432
    v_cvt_pk_bf16_f32 v99, v22, v23
    v_exp_f32 v26, v26
    v_exp_f32 v27, v27
    v_mfma_f32_32x32x16_bf16 v[176:191], v[168:171], v[72:75], v[176:191]
    ds_read_b128 v[152:155], v251 offset:12288
    v_cvt_pk_bf16_f32 v100, v24, v25
    v_exp_f32 v28, v28
    v_exp_f32 v29, v29
    v_cvt_pk_bf16_f32 v101, v26, v27
    v_mfma_f32_32x32x16_bf16 v[176:191], v[172:175], v[76:79], v[176:191]
    ds_read_b128 v[156:159], v251 offset:14336
    v_exp_f32 v30, v30
    v_exp_f32 v31, v31
    v_cvt_pk_bf16_f32 v102, v28, v29
    v_cvt_pk_bf16_f32 v103, v30, v31
    s_setprio 1
    s_waitcnt lgkmcnt(0)
    v_mfma_f32_32x32x16_bf16 v[16:31], v[128:131], v[120:123], v[224:239]
    ds_read_b128 v[160:163], v251 offset:8192
    s_add_u32 s13, s95, 2
    s_and_b32 s13, s13, 3
    s_add_u32 s13, s13, 3
    s_lshl_b32 s13, s13, 13
    s_add_u32 m0, s13, s99
    s_mul_i32 s13, s13, 7
    buffer_load_dwordx4 v1, s[64:67], s13 offen lds
    v_exp_f32 v32, v32
    v_exp_f32 v33, v33
    v_exp_f32 v34, v34
    v_exp_f32 v35, v35
    v_mfma_f32_32x32x16_bf16 v[16:31], v[132:135], v[124:127], v[16:31]
    ds_read_b128 v[164:167], v251 offset:10240
    v_cvt_pk_bf16_f32 v104, v32, v33
    v_exp_f32 v36, v36
    v_exp_f32 v37, v37
    v_cvt_pk_bf16_f32 v105, v34, v35
    v_mfma_f32_32x32x16_bf16 v[176:191], v[144:147], v[80:83], v[176:191]
    ds_read_b128 v[168:171], v251 offset:4096
    v_exp_f32 v38, v38
    v_exp_f32 v39, v39
    v_cvt_pk_bf16_f32 v106, v36, v37
    v_exp_f32 v40, v40
    v_exp_f32 v41, v41
    v_mfma_f32_32x32x16_bf16 v[176:191], v[148:151], v[84:87], v[176:191]
    ds_read_b128 v[172:175], v251 offset:6144
    v_cvt_pk_bf16_f32 v107, v38, v39
    v_exp_f32 v42, v42
    v_exp_f32 v43, v43
    v_mfma_f32_32x32x16_bf16 v[176:191], v[152:155], v[88:91], v[176:191]
    v_cvt_pk_bf16_f32 v108, v40, v41
    v_exp_f32 v44, v44
    v_exp_f32 v45, v45
    v_cvt_pk_bf16_f32 v109, v42, v43
    v_mfma_f32_32x32x16_bf16 v[176:191], v[156:159], v[92:95], v[176:191]
    v_exp_f32 v46, v46
    v_exp_f32 v47, v47
    v_cvt_pk_bf16_f32 v110, v44, v45
    v_cvt_pk_bf16_f32 v111, v46, v47
    s_setprio 0
    s_waitcnt lgkmcnt(0)
    v_mfma_f32_32x32x16_bf16 v[176:191], v[160:163], v[96:99], v[176:191]
    ds_read_b128 v[144:147], v251 offset:0
    v_exp_f32 v16, v16
    v_exp_f32 v17, v17
    v_exp_f32 v18, v18
    v_exp_f32 v19, v19
    v_cvt_pk_bf16_f32 v112, v16, v17
    v_exp_f32 v20, v20
    v_exp_f32 v21, v21
    v_mfma_f32_32x32x16_bf16 v[176:191], v[164:167], v[100:103], v[176:191]
    ds_read_b128 v[148:151], v251 offset:2048
    v_cvt_pk_bf16_f32 v113, v18, v19
    v_exp_f32 v22, v22
    v_exp_f32 v23, v23
    v_cvt_pk_bf16_f32 v114, v20, v21
    v_exp_f32 v24, v24
    v_exp_f32 v25, v25
    v_mfma_f32_32x32x16_bf16 v[176:191], v[168:171], v[104:107], v[176:191]
    s_add_u32 s13, s95, 3
    s_and_b32 s13, s13, 3
    s_add_u32 s13, s13, 3
    s_lshl_b32 s13, s13, 13
    s_add_u32 m0, s13, s99
    s_mul_i32 s13, s13, 7
    buffer_load_dwordx4 v1, s[64:67], s13 offen lds
    v_cvt_pk_bf16_f32 v115, v22, v23
    v_exp_f32 v26, v26
    v_exp_f32 v27, v27
    v_cvt_pk_bf16_f32 v116, v24, v25
    v_exp_f32 v28, v28
    v_exp_f32 v29, v29
    v_mfma_f32_32x32x16_bf16 v[176:191], v[172:175], v[108:111], v[176:191]
    v_cvt_pk_bf16_f32 v117, v26, v27
    v_exp_f32 v30, v30
    v_exp_f32 v31, v31
    v_cvt_pk_bf16_f32 v118, v28, v29
    v_cvt_pk_bf16_f32 v119, v30, v31
    s_waitcnt lgkmcnt(0)
    v_mfma_f32_32x32x16_bf16 v[176:191], v[144:147], v[112:115], v[176:191]
    v_mfma_f32_32x32x16_bf16 v[176:191], v[148:151], v[116:119], v[176:191]
    s_setprio 0
    s_nop 10
    v_subrev_u32 v13, 0x21800000, v188
    v_cmp_lt_u32 vcc, 0x3c000000, v13
    s_nop 0
    s_cmp_lg_u32 vcc_hi, 0
    s_cbranch_scc1 L_r_14
L_r_14b:
    v_mov_b32 v255, 0x100
    v_mul_f32 v13, v192, v188
    v_rcp_f32 v196, v13
    v_lshrrev_b32 v14, 1, v12
    v_mov_b32 v197, v196
    s_nop 1
    v_permlane32_swap_b32 v196, v197
    v_mul_f32 v176, v197, v176
    v_mul_f32 v177, v197, v177
    v_mul_f32 v178, v197, v178
    v_mul_f32 v179, v197, v179
    v_mul_f32 v180, v197, v180
    v_mul_f32 v181, v197, v181
    v_mul_f32 v182, v197, v182
    v_mul_f32 v183, v197, v183
    v_cvt_pk_bf16_f32 v200, v176, v177
    v_cvt_pk_bf16_f32 v201, v178, v179
    v_cvt_pk_bf16_f32 v202, v180, v181
    v_cvt_pk_bf16_f32 v203, v182, v183
    buffer_store_dwordx4 v[200:203], v12, s[48:51], s93 offen offset:0 sc1
    v_mul_f32 v184, v197, v184
    v_mul_f32 v185, v197, v185
    v_mul_f32 v186, v197, v186
    v_mul_f32 v187, v197, v187
    v_mul_f32 v188, v197, v188
    v_mul_f32 v189, v197, v189
    v_mul_f32 v190, v197, v190
    v_mul_f32 v191, v197, v191
    v_cvt_pk_bf16_f32 v204, v184, v185
    v_cvt_pk_bf16_f32 v205, v186, v187
    v_cvt_pk_bf16_f32 v206, v188, v189
    v_cvt_pk_bf16_f32 v207, v190, v191
    s_mov_b32 exec_hi, 0
    buffer_store_dwordx4 v[204:207], v12, s[48:51], s93 offen offset:1024 sc1
    s_not_b64 exec, exec
    buffer_store_dwordx2 v[204:205], v14, s[48:51], s93 offen offset:1280 sc1
    s_mov_b64 exec, -1
    s_branch L_pg_ab_f_go
.p2align 12
L_pg_ab_f_go:
L_join:
    s_cmp_ge_u32 s2, 224
    s_cbranch_scc0 L_fin
    s_waitcnt vmcnt(0)
    s_barrier
    s_mul_i32 s10, s6, 1792
    s_add_u32 s10, s10, 32768
    s_mov_b64 exec, 0x3fff
    buffer_atomic_add v255, v193, s[40:43], s10 offen sc1
    s_mov_b64 exec, -1
    s_endpgm
L_fin:
    s_mul_i32 s10, s4, 57344
    s_add_u32 s11, s10, 49152
    s_lshl_b32 s85, s10, 1
    s_sub_u32 s85, 57344, s85
    s_cmp_eq_u32 s4, 0
    s_cselect_b32 s98, s98, s99
    v_add3_u32 v6, v6, v7, s11
    v_lshrrev_b32 v13, 4, v0
    v_lshrrev_b32 v14, 5, v0
    v_and_b32 v15, 1, v13
    v_mul_u32_u24 v16, 3584, v14
    v_lshl_add_u32 v16, v15, 9, v16
    v_add_u32 v16, v16, v6
    v_lshlrev_b32 v17, 6, v14
    v_xor_b32 v16, v17, v16
    v_mul_u32_u24 v20, 3584, v13
    v_add_u32 v20, v20, v6
    v_lshl_or_b32 v34, v13, 1, v15
    v_xor_b32 v35, 1, v34
    v_mul_u32_u24 v24, 3584, v34
    v_mul_u32_u24 v28, 3584, v35
    v_add_u32 v28, v28, v6
    v_xor_b32 v6, 64, v6
    v_add_u32 v24, v24, v6
    v_xor_b32 v17, 32, v16
    v_xor_b32 v18, 64, v16
    v_xor_b32 v19, 96, v16
    v_xor_b32 v21, 32, v20
    v_xor_b32 v22, 64, v20
    v_xor_b32 v23, 96, v20
    v_xor_b32 v25, 32, v24
    v_xor_b32 v26, 64, v24
    v_xor_b32 v27, 96, v24
    v_xor_b32 v29, 32, v28
    v_xor_b32 v30, 64, v28
    v_xor_b32 v31, 96, v28
    s_waitcnt vmcnt(0)
    s_barrier
    s_mul_i32 s10, s6, 1792
    s_add_u32 s10, s10, 32768
    s_mov_b64 exec, 0x3fff
    buffer_atomic_add v255, v193, s[40:43], s10 offen sc1
    s_mov_b64 exec, -1
    s_add_u32 m0, s98, 0
    s_mov_b32 s13, 0
    buffer_load_dwordx4 v1, s[64:67], s13 offen lds
    s_add_u32 m0, s98, 8192
    s_mov_b32 s13, 57344
    buffer_load_dwordx4 v1, s[64:67], s13 offen lds
    s_add_u32 m0, s98, 16384
    s_mov_b32 s13, 114688
    buffer_load_dwordx4 v1, s[64:67], s13 offen lds
    v_mul_u32_u24 v32, 2048, v14
    v_lshl_add_u32 v32, v15, 9, v32
    v_lshl_add_u32 v32, v8, 4, v32
    v_mul_u32_u24 v33, 2048, v13
    v_lshl_add_u32 v33, v8, 4, v33
    v_lshlrev_b32 v8, 3, v8
    s_movk_i32 s10, 2048
    v_mad_u32_u24 v34, v34, s10, v8
    v_mad_u32_u24 v35, v35, s10, v8
    s_lshr_b32 s11, s7, 1
    s_lshl1_add_u32 s10, s95, s11
    s_lshl2_add_u32 s10, s10, s8
    s_mul_i32 s10, s10, 16384
    s_add_u32 s83, s10, 6291456
    s_add_u32 s84, s10, 6324224
    v_mov_b32 v14, 8192
    ds_read_b64_tr_b16 v[76:77], v16 offset:0
    ds_read_b64_tr_b16 v[78:79], v16 offset:1024
    ds_read_b64_tr_b16 v[80:81], v17 offset:0
    ds_read_b64_tr_b16 v[82:83], v17 offset:1024
    ds_read_b64_tr_b16 v[84:85], v18 offset:0
    ds_read_b64_tr_b16 v[86:87], v18 offset:1024
    ds_read_b64_tr_b16 v[88:89], v19 offset:0
    ds_read_b64_tr_b16 v[90:91], v19 offset:1024
    s_cmp_eq_u32 s4, 0
    s_cbranch_scc0 L_am_15
    s_add_u32 s13, s95, 2
    s_and_b32 s13, s13, 3
    s_add_u32 s13, s13, 3
    s_lshl_b32 s13, s13, 13
    s_add_u32 m0, s13, s98
    s_mul_i32 s13, s13, 7
    buffer_load_dwordx4 v1, s[64:67], s13 offen lds
L_am_15:
    ds_read_b64_tr_b16 v[92:93], v16 offset:7168
    ds_read_b64_tr_b16 v[94:95], v16 offset:8192
    ds_read_b64_tr_b16 v[96:97], v17 offset:7168
    ds_read_b64_tr_b16 v[98:99], v17 offset:8192
    ds_read_b64_tr_b16 v[100:101], v18 offset:7168
    ds_read_b64_tr_b16 v[102:103], v18 offset:8192
    ds_read_b64_tr_b16 v[104:105], v19 offset:7168
    ds_read_b64_tr_b16 v[106:107], v19 offset:8192
    s_cmp_eq_u32 s4, 0
    s_cbranch_scc0 L_am_16
    s_add_u32 s13, s95, 3
    s_and_b32 s13, s13, 3
    s_add_u32 s13, s13, 3
    s_lshl_b32 s13, s13, 13
    s_add_u32 m0, s13, s98
    s_mul_i32 s13, s13, 7
    buffer_load_dwordx4 v1, s[64:67], s13 offen lds
L_am_16:
    ds_read_b64_tr_b16 v[108:109], v16 offset:14336
    ds_read_b64_tr_b16 v[110:111], v16 offset:15360
    ds_read_b64_tr_b16 v[112:113], v17 offset:14336
    ds_read_b64_tr_b16 v[114:115], v17 offset:15360
    ds_read_b64_tr_b16 v[116:117], v18 offset:14336
    ds_read_b64_tr_b16 v[118:119], v18 offset:15360
    ds_read_b64_tr_b16 v[120:121], v19 offset:14336
    ds_read_b64_tr_b16 v[122:123], v19 offset:15360
    ds_read_b64_tr_b16 v[124:125], v16 offset:21504
    ds_read_b64_tr_b16 v[126:127], v16 offset:22528
    ds_read_b64_tr_b16 v[128:129], v17 offset:21504
    ds_read_b64_tr_b16 v[130:131], v17 offset:22528
    ds_read_b64_tr_b16 v[132:133], v18 offset:21504
    ds_read_b64_tr_b16 v[134:135], v18 offset:22528
    ds_read_b64_tr_b16 v[136:137], v19 offset:21504
    ds_read_b64_tr_b16 v[138:139], v19 offset:22528
    ds_read_b64_tr_b16 v[140:141], v20 offset:2048
    ds_read_b64_tr_b16 v[142:143], v20 offset:3072
    ds_read_b64_tr_b16 v[144:145], v21 offset:2048
    ds_read_b64_tr_b16 v[146:147], v21 offset:3072
    ds_read_b64_tr_b16 v[148:149], v22 offset:2048
    ds_read_b64_tr_b16 v[150:151], v22 offset:3072
    ds_read_b64_tr_b16 v[152:153], v23 offset:2048
    ds_read_b64_tr_b16 v[154:155], v23 offset:3072
    ds_read_b64_tr_b16 v[156:157], v20 offset:16384
    ds_read_b64_tr_b16 v[158:159], v20 offset:17408
    ds_read_b64_tr_b16 v[160:161], v21 offset:16384
    ds_read_b64_tr_b16 v[162:163], v21 offset:17408
    ds_read_b64_tr_b16 v[164:165], v22 offset:16384
    ds_read_b64_tr_b16 v[166:167], v22 offset:17408
    ds_read_b64_tr_b16 v[168:169], v23 offset:16384
    ds_read_b64_tr_b16 v[170:171], v23 offset:17408
    ds_read_b64_tr_b16 v[172:173], v24 offset:2560
    ds_read_b64_tr_b16 v[174:175], v28 offset:2560
    ds_read_b64_tr_b16 v[176:177], v25 offset:2560
    ds_read_b64_tr_b16 v[178:179], v29 offset:2560
    ds_read_b64_tr_b16 v[180:181], v26 offset:2560
    ds_read_b64_tr_b16 v[182:183], v30 offset:2560
    ds_read_b64_tr_b16 v[184:185], v27 offset:2560
    ds_read_b64_tr_b16 v[186:187], v31 offset:2560
    s_cmp_eq_u32 s3, 1
    s_cbranch_scc0 L_fe_18
    s_mov_b32 s94, 0
    v_mov_b32 v254, 0
    s_mov_b64 exec, 1
    buffer_atomic_umax v254, v9, s[48:51], 0 offen sc0 sc1
    buffer_atomic_umax v254, v9, s[48:51], 0 offen sc0 sc1
    buffer_atomic_umax v254, v9, s[48:51], 0 offen sc0 sc1
L_fs_17:
    s_mov_b64 exec, 1
    buffer_atomic_umax v254, v9, s[48:51], 0 offen sc0 sc1
    s_mov_b64 exec, -1
    s_add_u32 s94, s94, 1
    s_waitcnt vmcnt(3)
    v_readfirstlane_b32 s10, v254
    s_nop 0
    s_cmp_eq_u32 s10, 0x808
    s_cbranch_scc1 L_fe_18
    s_cmp_lt_u32 s94, 0x8000
    s_cbranch_scc1 L_fs_17
L_fe_18:
    s_cmp_eq_u32 s3, 1
    s_cbranch_scc1 L_w2ok
    s_waitcnt vmcnt(0)
L_w2ok:
    s_waitcnt lgkmcnt(0)
    s_barrier
    buffer_load_dwordx4 v[36:39], v32, s[48:51], s83 offen offset:0 sc1
    s_add_u32 s12, s83, 4096
    buffer_load_dwordx4 v[40:43], v32, s[48:51], s12 offen offset:0 sc1
    s_add_u32 s12, s83, 8192
    buffer_load_dwordx4 v[44:47], v32, s[48:51], s12 offen offset:0 sc1
    s_add_u32 s12, s83, 12288
    buffer_load_dwordx4 v[48:51], v32, s[48:51], s12 offen offset:0 sc1
    buffer_load_dwordx4 v[52:55], v33, s[48:51], s83 offen offset:1024 sc1
    v_add_u32 v16, s85, v16
    v_add_u32 v17, s85, v17
    v_add_u32 v18, s85, v18
    v_add_u32 v19, s85, v19
    v_add_u32 v20, s85, v20
    v_add_u32 v21, s85, v21
    v_add_u32 v22, s85, v22
    v_add_u32 v23, s85, v23
    v_add_u32 v24, s85, v24
    v_add_u32 v25, s85, v25
    v_add_u32 v26, s85, v26
    v_add_u32 v27, s85, v27
    v_add_u32 v28, s85, v28
    v_add_u32 v29, s85, v29
    v_add_u32 v30, s85, v30
    v_add_u32 v31, s85, v31
    ds_read_b64_tr_b16 v[188:189], v16 offset:0
    ds_read_b64_tr_b16 v[190:191], v16 offset:1024
    ds_read_b64_tr_b16 v[192:193], v17 offset:0
    ds_read_b64_tr_b16 v[194:195], v17 offset:1024
    ds_read_b64_tr_b16 v[196:197], v18 offset:0
    ds_read_b64_tr_b16 v[198:199], v18 offset:1024
    ds_read_b64_tr_b16 v[200:201], v19 offset:0
    ds_read_b64_tr_b16 v[202:203], v19 offset:1024
    ds_read_b64_tr_b16 v[204:205], v16 offset:7168
    ds_read_b64_tr_b16 v[206:207], v16 offset:8192
    ds_read_b64_tr_b16 v[208:209], v17 offset:7168
    ds_read_b64_tr_b16 v[210:211], v17 offset:8192
    ds_read_b64_tr_b16 v[212:213], v18 offset:7168
    ds_read_b64_tr_b16 v[214:215], v18 offset:8192
    ds_read_b64_tr_b16 v[216:217], v19 offset:7168
    ds_read_b64_tr_b16 v[218:219], v19 offset:8192
    s_waitcnt vmcnt(4)
    v_mfma_f32_16x16x32_bf16 v[60:63], v[76:79], v[36:39], 0
    s_add_u32 s12, s83, 8192
    buffer_load_dwordx4 v[56:59], v33, s[48:51], s12 offen offset:1024 sc1
    v_mfma_f32_16x16x32_bf16 v[64:67], v[80:83], v[36:39], 0
    ds_read_b64_tr_b16 v[220:221], v16 offset:14336
    ds_read_b64_tr_b16 v[222:223], v16 offset:15360
    v_mfma_f32_16x16x32_bf16 v[68:71], v[84:87], v[36:39], 0
    ds_read_b64_tr_b16 v[224:225], v17 offset:14336
    ds_read_b64_tr_b16 v[226:227], v17 offset:15360
    v_mfma_f32_16x16x32_bf16 v[72:75], v[88:91], v[36:39], 0
    s_waitcnt vmcnt(4)
    v_mfma_f32_16x16x32_bf16 v[60:63], v[92:95], v[40:43], v[60:63]
    buffer_load_dwordx2 v[36:37], v34, s[48:51], s83 offen offset:1536 sc1
    buffer_load_dwordx2 v[38:39], v35, s[48:51], s83 offen offset:1536 sc1
    v_mfma_f32_16x16x32_bf16 v[64:67], v[96:99], v[40:43], v[64:67]
    ds_read_b64_tr_b16 v[228:229], v18 offset:14336
    ds_read_b64_tr_b16 v[230:231], v18 offset:15360
    v_mfma_f32_16x16x32_bf16 v[68:71], v[100:103], v[40:43], v[68:71]
    ds_read_b64_tr_b16 v[232:233], v19 offset:14336
    ds_read_b64_tr_b16 v[234:235], v19 offset:15360
    v_mfma_f32_16x16x32_bf16 v[72:75], v[104:107], v[40:43], v[72:75]
    s_waitcnt vmcnt(5)
    v_mfma_f32_16x16x32_bf16 v[60:63], v[108:111], v[44:47], v[60:63]
    buffer_load_dwordx4 v[40:43], v32, s[48:51], s84 offen offset:0 sc1
    v_mfma_f32_16x16x32_bf16 v[64:67], v[112:115], v[44:47], v[64:67]
    ds_read_b64_tr_b16 v[236:237], v16 offset:21504
    ds_read_b64_tr_b16 v[238:239], v16 offset:22528
    v_mfma_f32_16x16x32_bf16 v[68:71], v[116:119], v[44:47], v[68:71]
    ds_read_b64_tr_b16 v[240:241], v17 offset:21504
    ds_read_b64_tr_b16 v[242:243], v17 offset:22528
    v_mfma_f32_16x16x32_bf16 v[72:75], v[120:123], v[44:47], v[72:75]
    s_waitcnt vmcnt(5)
    v_mfma_f32_16x16x32_bf16 v[60:63], v[124:127], v[48:51], v[60:63]
    s_add_u32 s12, s84, 4096
    buffer_load_dwordx4 v[44:47], v32, s[48:51], s12 offen offset:0 sc1
    v_mfma_f32_16x16x32_bf16 v[64:67], v[128:131], v[48:51], v[64:67]
    ds_read_b64_tr_b16 v[244:245], v18 offset:21504
    ds_read_b64_tr_b16 v[246:247], v18 offset:22528
    v_mfma_f32_16x16x32_bf16 v[68:71], v[132:135], v[48:51], v[68:71]
    ds_read_b64_tr_b16 v[248:249], v19 offset:21504
    ds_read_b64_tr_b16 v[250:251], v19 offset:22528
    v_mfma_f32_16x16x32_bf16 v[72:75], v[136:139], v[48:51], v[72:75]
    s_waitcnt vmcnt(5)
    v_mfma_f32_16x16x32_bf16 v[60:63], v[140:143], v[52:55], v[60:63]
    s_add_u32 s12, s84, 8192
    buffer_load_dwordx4 v[48:51], v32, s[48:51], s12 offen offset:0 sc1
    v_mfma_f32_16x16x32_bf16 v[64:67], v[144:147], v[52:55], v[64:67]
    ds_read_b64_tr_b16 v[76:77], v20 offset:2048
    ds_read_b64_tr_b16 v[78:79], v20 offset:3072
    v_mfma_f32_16x16x32_bf16 v[68:71], v[148:151], v[52:55], v[68:71]
    ds_read_b64_tr_b16 v[80:81], v21 offset:2048
    ds_read_b64_tr_b16 v[82:83], v21 offset:3072
    v_mfma_f32_16x16x32_bf16 v[72:75], v[152:155], v[52:55], v[72:75]
    s_waitcnt vmcnt(5)
    v_mfma_f32_16x16x32_bf16 v[60:63], v[156:159], v[56:59], v[60:63]
    s_add_u32 s12, s84, 12288
    buffer_load_dwordx4 v[52:55], v32, s[48:51], s12 offen offset:0 sc1
    v_mfma_f32_16x16x32_bf16 v[64:67], v[160:163], v[56:59], v[64:67]
    ds_read_b64_tr_b16 v[84:85], v22 offset:2048
    ds_read_b64_tr_b16 v[86:87], v22 offset:3072
    v_mfma_f32_16x16x32_bf16 v[68:71], v[164:167], v[56:59], v[68:71]
    ds_read_b64_tr_b16 v[88:89], v23 offset:2048
    ds_read_b64_tr_b16 v[90:91], v23 offset:3072
    v_mfma_f32_16x16x32_bf16 v[72:75], v[168:171], v[56:59], v[72:75]
    s_waitcnt vmcnt(4)
    v_mfma_f32_16x16x32_bf16 v[60:63], v[172:175], v[36:39], v[60:63]
    buffer_load_dwordx4 v[56:59], v33, s[48:51], s84 offen offset:1024 sc1
    v_mfma_f32_16x16x32_bf16 v[64:67], v[176:179], v[36:39], v[64:67]
    ds_read_b64_tr_b16 v[92:93], v20 offset:16384
    ds_read_b64_tr_b16 v[94:95], v20 offset:17408
    v_mfma_f32_16x16x32_bf16 v[68:71], v[180:183], v[36:39], v[68:71]
    ds_read_b64_tr_b16 v[96:97], v21 offset:16384
    ds_read_b64_tr_b16 v[98:99], v21 offset:17408
    v_mfma_f32_16x16x32_bf16 v[72:75], v[184:187], v[36:39], v[72:75]
    s_lshl_b32 s10, s7, 12
    s_add_u32 s10, s10, 16384
    v_add_u32 v3, s10, v12
    v_xor_b32 v4, 64, v2
    s_waitcnt vmcnt(4) lgkmcnt(15)
    v_mfma_f32_16x16x32_bf16 v[60:63], v[188:191], v[40:43], v[60:63]
    s_add_u32 s12, s84, 8192
    buffer_load_dwordx4 v[36:39], v33, s[48:51], s12 offen offset:1024 sc1
    v_mfma_f32_16x16x32_bf16 v[64:67], v[192:195], v[40:43], v[64:67]
    ds_read_b64_tr_b16 v[100:101], v22 offset:16384
    ds_read_b64_tr_b16 v[102:103], v22 offset:17408
    v_mfma_f32_16x16x32_bf16 v[68:71], v[196:199], v[40:43], v[68:71]
    ds_read_b64_tr_b16 v[104:105], v23 offset:16384
    ds_read_b64_tr_b16 v[106:107], v23 offset:17408
    v_mfma_f32_16x16x32_bf16 v[72:75], v[200:203], v[40:43], v[72:75]
    s_waitcnt vmcnt(4) lgkmcnt(15)
    v_mfma_f32_16x16x32_bf16 v[60:63], v[204:207], v[44:47], v[60:63]
    buffer_load_dwordx2 v[40:41], v34, s[48:51], s84 offen offset:1536 sc1
    buffer_load_dwordx2 v[42:43], v35, s[48:51], s84 offen offset:1536 sc1
    v_mfma_f32_16x16x32_bf16 v[64:67], v[208:211], v[44:47], v[64:67]
    ds_read_b64_tr_b16 v[108:109], v24 offset:2560
    ds_read_b64_tr_b16 v[110:111], v28 offset:2560
    v_mfma_f32_16x16x32_bf16 v[68:71], v[212:215], v[44:47], v[68:71]
    ds_read_b64_tr_b16 v[112:113], v25 offset:2560
    ds_read_b64_tr_b16 v[114:115], v29 offset:2560
    v_mfma_f32_16x16x32_bf16 v[72:75], v[216:219], v[44:47], v[72:75]
    s_waitcnt vmcnt(5) lgkmcnt(15)
    v_mfma_f32_16x16x32_bf16 v[60:63], v[220:223], v[48:51], v[60:63]
    v_mfma_f32_16x16x32_bf16 v[64:67], v[224:227], v[48:51], v[64:67]
    ds_read_b64_tr_b16 v[116:117], v26 offset:2560
    ds_read_b64_tr_b16 v[118:119], v30 offset:2560
    v_mfma_f32_16x16x32_bf16 v[68:71], v[228:231], v[48:51], v[68:71]
    ds_read_b64_tr_b16 v[120:121], v27 offset:2560
    ds_read_b64_tr_b16 v[122:123], v31 offset:2560
    v_mfma_f32_16x16x32_bf16 v[72:75], v[232:235], v[48:51], v[72:75]
    s_waitcnt vmcnt(4) lgkmcnt(15)
    v_mfma_f32_16x16x32_bf16 v[60:63], v[236:239], v[52:55], v[60:63]
    v_mfma_f32_16x16x32_bf16 v[64:67], v[240:243], v[52:55], v[64:67]
    v_mfma_f32_16x16x32_bf16 v[68:71], v[244:247], v[52:55], v[68:71]
    v_mfma_f32_16x16x32_bf16 v[72:75], v[248:251], v[52:55], v[72:75]
    s_waitcnt vmcnt(3) lgkmcnt(15)
    v_mfma_f32_16x16x32_bf16 v[60:63], v[76:79], v[56:59], v[60:63]
    v_mfma_f32_16x16x32_bf16 v[64:67], v[80:83], v[56:59], v[64:67]
    v_mfma_f32_16x16x32_bf16 v[68:71], v[84:87], v[56:59], v[68:71]
    v_mfma_f32_16x16x32_bf16 v[72:75], v[88:91], v[56:59], v[72:75]
    s_cmp_eq_u32 s8, 0
    s_cbranch_scc0 L_take
    s_waitcnt vmcnt(2) lgkmcnt(8)
    v_mfma_f32_16x16x32_bf16 v[60:63], v[92:95], v[36:39], v[60:63]
    v_mfma_f32_16x16x32_bf16 v[64:67], v[96:99], v[36:39], v[64:67]
    v_mfma_f32_16x16x32_bf16 v[68:71], v[100:103], v[36:39], v[68:71]
    v_mfma_f32_16x16x32_bf16 v[72:75], v[104:107], v[36:39], v[72:75]
    s_waitcnt vmcnt(0) lgkmcnt(0)
    v_mfma_f32_16x16x32_bf16 v[60:63], v[108:111], v[40:43], v[60:63]
    v_mfma_f32_16x16x32_bf16 v[64:67], v[112:115], v[40:43], v[64:67]
    v_mfma_f32_16x16x32_bf16 v[68:71], v[116:119], v[40:43], v[68:71]
    v_mfma_f32_16x16x32_bf16 v[72:75], v[120:123], v[40:43], v[72:75]
    s_nop 4
    ds_write_b128 v3, v[60:63] offset:2048
    ds_write_b128 v3, v[64:67] offset:3072
    ds_write_b128 v3, v[68:71] offset:0
    ds_write_b128 v3, v[72:75] offset:1024
    s_waitcnt lgkmcnt(0)
    s_barrier
    s_branch L_done
L_take:
    s_barrier
    ds_read_b128 v[236:239], v3 offset:0
    ds_read_b128 v[240:243], v3 offset:1024
    ds_read_b128 v[244:247], v3 offset:2048
    ds_read_b128 v[248:251], v3 offset:3072
    s_waitcnt vmcnt(2) lgkmcnt(12)
    v_mfma_f32_16x16x32_bf16 v[60:63], v[92:95], v[36:39], v[60:63]
    v_mfma_f32_16x16x32_bf16 v[64:67], v[96:99], v[36:39], v[64:67]
    v_mfma_f32_16x16x32_bf16 v[68:71], v[100:103], v[36:39], v[68:71]
    v_mfma_f32_16x16x32_bf16 v[72:75], v[104:107], v[36:39], v[72:75]
    s_waitcnt vmcnt(0) lgkmcnt(4)
    v_mfma_f32_16x16x32_bf16 v[60:63], v[108:111], v[40:43], v[60:63]
    v_mfma_f32_16x16x32_bf16 v[64:67], v[112:115], v[40:43], v[64:67]
    v_mfma_f32_16x16x32_bf16 v[68:71], v[116:119], v[40:43], v[68:71]
    v_mfma_f32_16x16x32_bf16 v[72:75], v[120:123], v[40:43], v[72:75]
    s_waitcnt lgkmcnt(0)
    s_nop 3
    v_add_f32 v60, v60, v236
    v_add_f32 v61, v61, v237
    v_add_f32 v62, v62, v238
    v_add_f32 v63, v63, v239
    v_add_f32 v64, v64, v240
    v_add_f32 v65, v65, v241
    v_add_f32 v66, v66, v242
    v_add_f32 v67, v67, v243
    v_cvt_pk_bf16_f32 v236, v60, v61
    v_cvt_pk_bf16_f32 v237, v62, v63
    v_cvt_pk_bf16_f32 v238, v64, v65
    v_cvt_pk_bf16_f32 v239, v66, v67
    s_nop 0
    v_permlane16_swap_b32 v236, v238
    v_permlane16_swap_b32 v237, v239
    buffer_store_dwordx4 v[236:239], v2, s[56:59], 0 offen sc1
    v_add_f32 v68, v68, v244
    v_add_f32 v69, v69, v245
    v_add_f32 v70, v70, v246
    v_add_f32 v71, v71, v247
    v_add_f32 v72, v72, v248
    v_add_f32 v73, v73, v249
    v_add_f32 v74, v74, v250
    v_add_f32 v75, v75, v251
    v_cvt_pk_bf16_f32 v240, v68, v69
    v_cvt_pk_bf16_f32 v241, v70, v71
    v_cvt_pk_bf16_f32 v242, v72, v73
    v_cvt_pk_bf16_f32 v243, v74, v75
    s_nop 0
    v_permlane16_swap_b32 v240, v242
    v_permlane16_swap_b32 v241, v243
    buffer_store_dwordx4 v[240:243], v4, s[56:59], 0 offen sc1
L_done:
L_exit:
    s_endpgm
L_r_11:
    s_mov_b32 s94, 0
L_pl_19:
    buffer_load_dword v254, v198, s[68:71], 0 offen sc1
    s_add_u32 s94, s94, 1
    s_waitcnt vmcnt(0)
    v_cmp_gt_u32 vcc, 1, v254
    s_cmp_lt_u32 s94, 0x8000
    s_cbranch_scc0 L_pd_20
    s_cbranch_vccnz L_pl_19
L_pd_20:
    s_branch L_r_11b
L_r_12:
    s_mov_b32 s94, 0
L_pl_21:
    v_mov_b32 v254, 64
    s_mov_b64 exec, 63
    v_mov_b32 v254, 0
    buffer_atomic_or v254, v198, s[68:71], 0 offen sc0 sc1
    s_mov_b64 exec, -1
    s_add_u32 s94, s94, 1
    s_waitcnt vmcnt(0)
    v_cmp_gt_u32 vcc, 1, v254
    s_cmp_lt_u32 s94, 0x8000
    s_cbranch_scc0 L_pd_22
    s_cbranch_vccnz L_pl_21
L_pd_22:
    s_branch L_r_12b
L_r_13:
    s_mov_b32 s94, 0
L_pl_23:
    v_mov_b32 v254, 64
    s_mov_b64 exec, 63
    v_mov_b32 v254, 0
    buffer_atomic_or v254, v198, s[68:71], 0 offen sc0 sc1
    s_mov_b64 exec, -1
    s_add_u32 s94, s94, 1
    s_waitcnt vmcnt(0)
    v_cmp_gt_u32 vcc, 1, v254
    s_cmp_lt_u32 s94, 0x8000
    s_cbranch_scc0 L_pd_24
    s_cbranch_vccnz L_pl_23
L_pd_24:
    s_branch L_r_13b
L_r_8:
    s_cmp_eq_u32 s3, 3
    s_cbranch_scc0 L_h1
    v_min_u32 v13, 39, v0
    v_lshlrev_b32 v13, 7, v13
    s_mul_i32 s10, s6, 5120
    v_mov_b32 v14, 0
    buffer_store_dword v14, v13, s[48:51], s10 offen sc1
L_h1:
    s_barrier
    s_lshl2_add_u32 s12, s6, s7
    v_min_u32 v13, 48, v0
    v_mul_u32_u24 v14, 37, v13
    v_lshrrev_b32 v14, 8, v14
    v_mul_u32_u24 v14, 14, v14
    v_add_lshl_u32 v15, v13, v14, 7
    s_mul_i32 s10, s12, 18816
    v_add_u32 v15, s10, v15
    s_cmp_eq_u32 s8, 0
    s_cselect_b32 s72, s18, s26
    s_cselect_b32 s73, s19, s27
    s_cselect_b32 s10, 1792, 0
    s_mov_b32 s74, 1204224
    s_cselect_b32 s72, s22, s28
    s_cselect_b32 s73, s23, s29
    s_mov_b32 s74, 401408
    s_mul_i32 s10, s12, 6272
    v_lshlrev_b32 v13, 7, v13
    buffer_load_dword v164, v13, s[72:75], s10 offen
    s_mov_b32 s74, 0
    s_branch L_r_8b
L_r_9:
    s_waitcnt vmcnt(1)
    s_lshl_b32 s10, s6, 2
    v_mov_b32 v255, 1
    s_mov_b64 exec, 1
    buffer_store_dword v255, off, s[68:71], s10 sc1
    s_mov_b64 exec, -1
    s_branch L_r_9b
L_r_10:
    s_add_u32 m0, s15, 17408
    s_nop 0
    buffer_load_dwordx4 v2, s[40:43], s77 offen lds
    s_waitcnt vmcnt(1)
    s_barrier
    ds_read_b128 v[16:19], v6 offset:0
    ds_read_b128 v[20:23], v7 offset:0
    ds_read_b128 v[24:27], v8 offset:0
    ds_read_b128 v[28:31], v9 offset:0
    s_add_u32 m0, s15, 32768
    s_nop 0
    buffer_load_dwordx4 v1, s[40:43], s78 offen lds
    s_add_u32 m0, s15, 33792
    s_nop 0
    buffer_load_dwordx4 v2, s[40:43], s78 offen lds
    s_waitcnt lgkmcnt(0)
    s_waitcnt vmcnt(2)
    s_barrier
    ds_read_b128 v[32:35], v6 offset:16384
    ds_read_b128 v[36:39], v7 offset:16384
    ds_read_b128 v[40:43], v8 offset:16384
    ds_read_b128 v[44:47], v9 offset:16384
    s_add_u32 m0, s15, 0
    s_nop 0
    buffer_load_dwordx4 v1, s[40:43], s79 offen lds
    s_add_u32 m0, s15, 1024
    s_nop 0
    buffer_load_dwordx4 v2, s[40:43], s79 offen lds
    s_waitcnt lgkmcnt(0)
    s_waitcnt vmcnt(2)
    s_barrier
    ds_read_b128 v[48:51], v6 offset:32768
    ds_read_b128 v[52:55], v7 offset:32768
    ds_read_b128 v[56:59], v8 offset:32768
    ds_read_b128 v[60:63], v9 offset:32768
    ds_read_u16 v152, v193
    s_add_u32 m0, s15, 16384
    s_nop 0
    buffer_load_dwordx4 v1, s[40:43], s80 offen lds
    s_add_u32 m0, s15, 17408
    s_nop 0
    buffer_load_dwordx4 v2, s[40:43], s80 offen lds
    s_waitcnt lgkmcnt(0)
    s_waitcnt vmcnt(2)
    s_barrier
    ds_read_b128 v[64:67], v6 offset:0
    ds_read_b128 v[68:71], v7 offset:0
    ds_read_b128 v[72:75], v8 offset:0
    ds_read_b128 v[76:79], v9 offset:0
    s_add_u32 m0, s15, 32768
    s_nop 0
    buffer_load_dwordx4 v1, s[40:43], s81 offen lds
    s_add_u32 m0, s15, 33792
    s_nop 0
    buffer_load_dwordx4 v2, s[40:43], s81 offen lds
    s_waitcnt lgkmcnt(0)
    s_waitcnt vmcnt(2)
    s_barrier
    ds_read_b128 v[80:83], v6 offset:16384
    ds_read_b128 v[84:87], v7 offset:16384
    ds_read_b128 v[88:91], v8 offset:16384
    ds_read_b128 v[92:95], v9 offset:16384
    s_add_u32 m0, s15, 0
    s_nop 0
    buffer_load_dwordx4 v1, s[40:43], s82 offen lds
    s_add_u32 m0, s15, 1024
    s_nop 0
    buffer_load_dwordx4 v2, s[40:43], s82 offen lds
    s_waitcnt lgkmcnt(0)
    s_waitcnt vmcnt(2)
    s_barrier
    ds_read_b128 v[96:99], v6 offset:32768
    ds_read_b128 v[100:103], v7 offset:32768
    ds_read_b128 v[104:107], v8 offset:32768
    ds_read_b128 v[108:111], v9 offset:32768
    s_waitcnt lgkmcnt(0)
    s_waitcnt vmcnt(0)
    s_barrier
    ds_read_b128 v[112:115], v6 offset:0
    ds_read_b128 v[116:119], v7 offset:0
    ds_read_b128 v[120:123], v8 offset:0
    ds_read_b128 v[124:127], v9 offset:0
    s_waitcnt lgkmcnt(0)
    s_barrier
    v_mov_b32 v153, 0
    v_mov_b32 v154, v152
    v_mov_b32 v155, 0
    ds_write_b128 v199, v[152:155]
    s_add_u32 m0, s14, 16384
    s_mov_b64 exec, s[90:91]
    buffer_load_dwordx4 v5, s[44:47], s83 offen lds
    s_mov_b64 exec, -1
    s_add_u32 m0, s14, 24576
    s_mov_b64 exec, s[90:91]
    buffer_load_dwordx4 v5, s[44:47], s84 offen lds
    s_mov_b64 exec, -1
    s_add_u32 m0, s14, 32768
    s_mov_b64 exec, s[90:91]
    buffer_load_dwordx4 v5, s[44:47], s85 offen lds
    s_mov_b64 exec, -1
    s_lshl2_add_u32 s10, s6, s7
    s_lshl_b32 s10, s10, 5
    s_lshr_b32 s11, s93, 4
    s_lshl1_add_u32 s11, s11, s8
    s_add_u32 s10, s10, s11
    s_mul_i32 s10, s10, 2048
    s_add_u32 s93, s10, 6291456
    v_mov_b32 v255, 1
    v_lshlrev_b32 v193, 7, v0
    s_mov_b32 s40, s48
    s_mov_b32 s41, s49
    s_cmp_eq_u32 s3, 0
    s_cselect_b32 s42, 81920, 0
    buffer_load_dword v254, v198, s[68:71], 0 offen sc1
    v_bfe_u32 v13, v0, 2, 2
    v_and_b32 v14, 3, v0
    v_lshlrev_b32 v14, 3, v14
    v_lshl_add_u32 v14, v13, 7, v14
    s_mul_i32 s10, s8, 28672
    v_add_u32 v144, s10, v14
    v_lshrrev_b32 v13, 1, v13
    s_lshl_b32 s10, s8, 1
    v_xor_b32 v13, s10, v13
    v_bfe_u32 v14, v0, 4, 1
    v_lshlrev_b32 v14, 1, v14
    v_xor_b32 v13, v14, v13
    v_lshlrev_b32 v145, 5, v13
    v_and_b32 v13, 15, v0
    s_and_b32 s10, s7, 1
    s_lshl_b32 s10, s10, 4
    v_add_u32 v146, s10, v13
    s_mul_i32 s10, s95, 7
    s_add_u32 s10, s10, s96
    s_lshl_b32 s10, s10, 7
    s_add_u32 s10, s10, 32768
    v_mov_b32 v147, s10
    v_and_b32 v148, 15, v0
    s_lshl_b32 s10, s95, 6
    s_lshl_b32 s11, s7, 4
    s_add_u32 s10, s10, s11
    v_add_u32 v148, s10, v148
    v_mul_u32_u24 v148, 896, v148
    v_bfe_u32 v13, v0, 4, 1
    v_lshl_add_u32 v148, v13, 5, v148
    v_lshrrev_b32 v13, 5, v0
    v_lshl_add_u32 v148, v13, 4, v148
    s_lshl_b32 s10, s96, 7
    s_lshl_b32 s11, s8, 6
    s_add_u32 s10, s10, s11
    v_add_u32 v148, s10, v148
    s_lshl_b32 s10, s7, 12
    s_lshl_b32 s11, s8, 11
    s_add_u32 s1, s10, s11
    s_add_u32 s10, s1, 49152
    v_add_u32 v252, s10, v12
    v_lshrrev_b32 v13, 5, v0
    s_lshl_b32 s11, s8, 11
    v_mul_u32_u24 v13, s11, v13
    v_sub_u32 v253, v252, v13
    v_add_u32 v253, 1024, v253
    v_and_b32 v13, 31, v0
    s_mul_i32 s10, s8, 28
    v_add_u32 v14, s10, v13
    s_lshl_b32 s10, s8, 5
    v_or_b32 v13, s10, v13
    v_cmp_eq_u32 vcc, 28, v13
    s_nop 1
    v_cndmask_b32 v14, v14, 60, vcc
    v_lshrrev_b32 v13, 5, v0
    v_lshl_add_u32 v14, v13, 6, v14
    s_lshl_b32 s10, s7, 12
    s_add_u32 s10, s10, 0
    v_lshl_add_u32 v251, v14, 4, s10
    s_sub_u32 s0, s8, 1
    v_or_b32 v250, s0, v11
    s_not_b32 s10, s0
    v_or_b32 v249, s10, v11
    v_min_u32 v13, 11, v0
    v_lshrrev_b32 v14, 2, v13
    v_cmp_ge_u32 vcc, s6, v14
    v_mov_b32 v15, s92
    s_nop 0
    v_cndmask_b32 v156, 0, v15, vcc
    v_mov_b32 v157, v156
    v_mov_b32 v158, v156
    v_mov_b32 v159, v156
    v_sub_u32 v14, 2, v14
    v_lshlrev_b32 v14, 14, v14
    v_bfe_u32 v15, v13, 1, 1
    v_lshl_add_u32 v14, v15, 10, v14
    v_and_b32 v15, 1, v13
    v_lshl_add_u32 v14, v15, 6, v14
    v_add_u32 v248, s1, v14
    s_mul_i32 s92, s5, 3584
    s_add_u32 s92, s92, s39
    s_lshl_b32 s10, s8, 11
    s_add_u32 s92, s92, s10
    s_mul_i32 s97, s5, 896
    s_add_u32 s97, s97, s39
    s_mul_i32 s10, s8, 14336
    s_add_u32 s97, s97, s10
    s_mov_b32 s32, s48
    s_mov_b32 s33, s49
    s_cmp_ge_u32 s6, 1
    s_cselect_b32 s34, 10485760, 0
    s_mov_b32 s52, s48
    s_mov_b32 s53, s49
    s_cmp_ge_u32 s6, 2
    s_cselect_b32 s54, 10485760, 0
    v_mov_b32 v6, v144
    v_mov_b32 v7, v145
    v_mov_b32 v8, v146
    v_mov_b32 v9, v147
    v_lshrrev_b32 v13, 3, v0
    v_and_b32 v14, 7, v0
    v_bfe_u32 v15, v0, 4, 2
    v_lshlrev_b32 v15, 1, v15
    v_xor_b32 v14, v15, v14
    s_lshl_b32 s10, s3, 3
    v_add_u32 v1, s10, v13
    v_mul_u32_u24 v1, 896, v1
    v_lshl_add_u32 v1, v14, 4, v1
    s_lshl_b32 s10, s96, 7
    v_add_u32 v1, s10, v1
    s_add_u32 s98, s14, 106496
    s_add_u32 s99, s14, 49152
    s_and_b32 s76, s95, 3
    s_lshl_b32 s76, s76, 14
    s_add_u32 s77, s76, 8192
    s_cmp_eq_u32 s77, 57344
    s_cselect_b32 s77, 0, s77
    s_add_u32 s78, s77, 8192
    s_cmp_eq_u32 s78, 57344
    s_cselect_b32 s78, 0, s78
    s_add_u32 s79, s78, 8192
    s_cmp_eq_u32 s79, 57344
    s_cselect_b32 s79, 0, s79
    s_add_u32 s80, s79, 8192
    s_cmp_eq_u32 s80, 57344
    s_cselect_b32 s80, 0, s80
    s_add_u32 s81, s80, 8192
    s_cmp_eq_u32 s81, 57344
    s_cselect_b32 s81, 0, s81
    s_add_u32 s82, s81, 8192
    s_cmp_eq_u32 s82, 57344
    s_cselect_b32 s82, 0, s82
    v_mov_b32 v2, v148
    s_add_u32 m0, s14, 40960
    s_mov_b64 exec, s[90:91]
    buffer_load_dwordx4 v5, s[44:47], s86 offen lds
    s_mov_b64 exec, -1
    s_add_u32 m0, s14, 0
    s_mov_b64 exec, s[90:91]
    buffer_load_dwordx4 v5, s[44:47], s87 offen lds
    s_mov_b64 exec, -1
    s_add_u32 m0, s14, 8192
    s_mov_b64 exec, s[90:91]
    buffer_load_dwordx4 v5, s[44:47], s88 offen lds
    s_mov_b64 exec, -1
    s_add_u32 m0, s14, 98304
    s_mov_b64 exec, s[90:91]
    buffer_load_dwordx4 v5, s[44:47], s89 offen lds
    s_mov_b64 exec, -1
    s_waitcnt vmcnt(4)
    v_cmp_gt_u32 vcc, 1, v254
    s_nop 0
    s_cbranch_vccnz L_r_25
L_r_25b:
    v_mov_b32 v198, v194
    s_mov_b32 s68, s48
    s_mov_b32 s69, s49
    s_cmp_eq_u32 s3, 1
    s_cselect_b32 s70, 81920, 0
    s_cselect_b32 s9, 0, 64
    s_waitcnt vmcnt(0) lgkmcnt(0)
    s_branch L_qphase
    s_branch L_r_10b
L_r_14:
    s_lshl2_add_u32 s10, s6, s7
    s_min_u32 s10, s10, 8
    s_sub_u32 s11, 8, s10
    s_mov_b32 s97, 0xff800000
    v_mov_b32 v15, s97
    v_xor_b32 v208, s97, v224
    v_xor_b32 v209, s97, v225
    v_xor_b32 v210, s97, v226
    v_xor_b32 v211, s97, v227
    v_xor_b32 v212, s97, v228
    v_xor_b32 v213, s97, v229
    v_xor_b32 v214, s97, v230
    v_xor_b32 v215, s97, v231
    v_xor_b32 v216, s97, v232
    v_xor_b32 v217, s97, v233
    v_xor_b32 v218, s97, v234
    v_xor_b32 v219, s97, v235
    v_xor_b32 v220, s97, v236
    v_xor_b32 v221, s97, v237
    v_xor_b32 v222, s97, v238
    v_xor_b32 v223, s97, v239
    v_and_b32 v252, 0xfff, v252
    v_and_b32 v253, 0xfff, v253
    s_mov_b32 s12, s11
L_sl_1:
    s_mul_i32 s10, s12, 28672
    s_mul_i32 s13, s5, 3584
    s_add_u32 s10, s10, s13
    s_add_u32 s10, s10, s39
    s_add_u32 s10, s10, 819200
    buffer_load_dwordx4 v[128:131], v252, s[48:51], s10 offen sc1
    buffer_load_dwordx4 v[132:135], v253, s[48:51], s10 offen sc1
    s_waitcnt vmcnt(0)
    v_mfma_f32_32x32x16_bf16 v[16:31], v[128:131], v[120:123], 0
    v_mfma_f32_32x32x16_bf16 v[16:31], v[132:135], v[124:127], v[16:31]
    s_nop 15
    s_cmp_eq_u32 s12, 8
    s_cbranch_scc0 L_sl_a1
    v_add_f32 v16, v208, v16
    v_add_f32 v17, v209, v17
    v_add_f32 v18, v210, v18
    v_add_f32 v19, v211, v19
    v_add_f32 v20, v212, v20
    v_add_f32 v21, v213, v21
    v_add_f32 v22, v214, v22
    v_add_f32 v23, v215, v23
    v_add_f32 v24, v216, v24
    v_add_f32 v25, v217, v25
    v_add_f32 v26, v218, v26
    v_add_f32 v27, v219, v27
    v_add_f32 v28, v220, v28
    v_add_f32 v29, v221, v29
    v_add_f32 v30, v222, v30
    v_add_f32 v31, v223, v31
L_sl_a1:
    s_cmp_eq_u32 s12, 0
    s_cbranch_scc0 L_sl_b1
    v_add_f32 v16, v224, v16
    v_add_f32 v17, v225, v17
    v_add_f32 v18, v226, v18
    v_add_f32 v19, v227, v19
    v_add_f32 v20, v228, v20
    v_add_f32 v21, v229, v21
    v_add_f32 v22, v230, v22
    v_add_f32 v23, v231, v23
    v_add_f32 v24, v232, v24
    v_add_f32 v25, v233, v25
    v_add_f32 v26, v234, v26
    v_add_f32 v27, v235, v27
    v_add_f32 v28, v236, v28
    v_add_f32 v29, v237, v29
    v_add_f32 v30, v238, v30
    v_add_f32 v31, v239, v31
L_sl_b1:
    v_max3_f32 v15, v15, v16, v17
    v_max3_f32 v15, v15, v18, v19
    v_max3_f32 v15, v15, v20, v21
    v_max3_f32 v15, v15, v22, v23
    v_max3_f32 v15, v15, v24, v25
    v_max3_f32 v15, v15, v26, v27
    v_max3_f32 v15, v15, v28, v29
    v_max3_f32 v15, v15, v30, v31
    s_add_u32 s12, s12, 1
    s_cmp_le_u32 s12, 8
    s_cbranch_scc1 L_sl_1
    v_mov_b32 v13, v15
    s_nop 1
    v_permlane32_swap_b32 v15, v13
    v_max_f32 v15, v15, v13
    v_mov_b32 v176, 0
    v_mov_b32 v177, 0
    v_mov_b32 v178, 0
    v_mov_b32 v179, 0
    v_mov_b32 v180, 0
    v_mov_b32 v181, 0
    v_mov_b32 v182, 0
    v_mov_b32 v183, 0
    v_mov_b32 v184, 0
    v_mov_b32 v185, 0
    v_mov_b32 v186, 0
    v_mov_b32 v187, 0
    v_mov_b32 v188, 0
    v_mov_b32 v189, 0
    v_mov_b32 v190, 0
    v_mov_b32 v191, 0
    s_mov_b32 s12, s11
L_sl_2:
    s_mul_i32 s10, s12, 28672
    s_mul_i32 s13, s5, 3584
    s_add_u32 s10, s10, s13
    s_add_u32 s10, s10, s39
    s_add_u32 s10, s10, 819200
    buffer_load_dwordx4 v[128:131], v252, s[48:51], s10 offen sc1
    buffer_load_dwordx4 v[132:135], v253, s[48:51], s10 offen sc1
    s_waitcnt vmcnt(0)
    v_mfma_f32_32x32x16_bf16 v[16:31], v[128:131], v[120:123], 0
    v_mfma_f32_32x32x16_bf16 v[16:31], v[132:135], v[124:127], v[16:31]
    s_nop 15
    s_cmp_eq_u32 s12, 8
    s_cbranch_scc0 L_sl_a2
    v_add_f32 v16, v208, v16
    v_add_f32 v17, v209, v17
    v_add_f32 v18, v210, v18
    v_add_f32 v19, v211, v19
    v_add_f32 v20, v212, v20
    v_add_f32 v21, v213, v21
    v_add_f32 v22, v214, v22
    v_add_f32 v23, v215, v23
    v_add_f32 v24, v216, v24
    v_add_f32 v25, v217, v25
    v_add_f32 v26, v218, v26
    v_add_f32 v27, v219, v27
    v_add_f32 v28, v220, v28
    v_add_f32 v29, v221, v29
    v_add_f32 v30, v222, v30
    v_add_f32 v31, v223, v31
L_sl_a2:
    s_cmp_eq_u32 s12, 0
    s_cbranch_scc0 L_sl_b2
    v_add_f32 v16, v224, v16
    v_add_f32 v17, v225, v17
    v_add_f32 v18, v226, v18
    v_add_f32 v19, v227, v19
    v_add_f32 v20, v228, v20
    v_add_f32 v21, v229, v21
    v_add_f32 v22, v230, v22
    v_add_f32 v23, v231, v23
    v_add_f32 v24, v232, v24
    v_add_f32 v25, v233, v25
    v_add_f32 v26, v234, v26
    v_add_f32 v27, v235, v27
    v_add_f32 v28, v236, v28
    v_add_f32 v29, v237, v29
    v_add_f32 v30, v238, v30
    v_add_f32 v31, v239, v31
L_sl_b2:
    s_lshl_b32 s13, s12, 12
    v_add_u32 v14, s13, v251
    ds_read_b128 v[144:147], v14
    ds_read_b128 v[148:151], v14 offset:2048
    v_sub_f32 v16, v16, v15
    v_sub_f32 v17, v17, v15
    v_sub_f32 v18, v18, v15
    v_sub_f32 v19, v19, v15
    v_sub_f32 v20, v20, v15
    v_sub_f32 v21, v21, v15
    v_sub_f32 v22, v22, v15
    v_sub_f32 v23, v23, v15
    v_sub_f32 v24, v24, v15
    v_sub_f32 v25, v25, v15
    v_sub_f32 v26, v26, v15
    v_sub_f32 v27, v27, v15
    v_sub_f32 v28, v28, v15
    v_sub_f32 v29, v29, v15
    v_sub_f32 v30, v30, v15
    v_sub_f32 v31, v31, v15
    v_exp_f32 v16, v16
    v_exp_f32 v17, v17
    v_exp_f32 v18, v18
    v_exp_f32 v19, v19
    v_exp_f32 v20, v20
    v_exp_f32 v21, v21
    v_exp_f32 v22, v22
    v_exp_f32 v23, v23
    v_exp_f32 v24, v24
    v_exp_f32 v25, v25
    v_exp_f32 v26, v26
    v_exp_f32 v27, v27
    v_exp_f32 v28, v28
    v_exp_f32 v29, v29
    v_exp_f32 v30, v30
    v_exp_f32 v31, v31
    v_cvt_pk_bf16_f32 v48, v16, v17
    v_cvt_pk_bf16_f32 v49, v18, v19
    v_cvt_pk_bf16_f32 v50, v20, v21
    v_cvt_pk_bf16_f32 v51, v22, v23
    v_cvt_pk_bf16_f32 v52, v24, v25
    v_cvt_pk_bf16_f32 v53, v26, v27
    v_cvt_pk_bf16_f32 v54, v28, v29
    v_cvt_pk_bf16_f32 v55, v30, v31
    s_waitcnt lgkmcnt(0)
    v_mfma_f32_32x32x16_bf16 v[176:191], v[144:147], v[48:51], v[176:191]
    v_mfma_f32_32x32x16_bf16 v[176:191], v[148:151], v[52:55], v[176:191]
    s_add_u32 s12, s12, 1
    s_cmp_le_u32 s12, 8
    s_cbranch_scc1 L_sl_2
    s_nop 15
    s_branch L_r_14b
L_r_25:
    s_mov_b32 s94, 0
L_pl_26:
    buffer_load_dword v254, v198, s[68:71], 0 offen sc1
    s_add_u32 s94, s94, 1
    s_waitcnt vmcnt(0)
    v_cmp_gt_u32 vcc, 1, v254
    s_cmp_lt_u32 s94, 0x8000
    s_cbranch_scc0 L_pd_27
    s_cbranch_vccnz L_pl_26
L_pd_27:
    s_branch L_r_25b
L_fms_k:
    v_mfma_f32_32x32x16_bf16 v[208:223], v[240:243], v[200:203], 0
    v_mfma_f32_32x32x16_bf16 v[208:223], v[244:247], v[204:207], v[208:223]
    s_nop 11
    v_bfi_b32 v220, v11, v220, v216
    v_bfi_b32 v221, v11, v221, v216
    v_bfi_b32 v222, v11, v222, v216
    v_bfi_b32 v223, v11, v223, v216
    v_max3_f32 v248, v208, v209, v210
    v_min3_f32 v249, v208, v209, v210
    v_max3_f32 v248, v248, v211, v212
    v_min3_f32 v249, v249, v211, v212
    v_max3_f32 v248, v248, v213, v214
    v_min3_f32 v249, v249, v213, v214
    v_max3_f32 v248, v248, v215, v216
    v_min3_f32 v249, v249, v215, v216
    v_max3_f32 v248, v248, v217, v218
    v_min3_f32 v249, v249, v217, v218
    v_max3_f32 v248, v248, v219, v220
    v_min3_f32 v249, v249, v219, v220
    v_max3_f32 v248, v248, v221, v222
    v_min3_f32 v249, v249, v221, v222
    v_max_f32 v248, v248, v223
    v_min_f32 v249, v249, v223
    v_mov_b32 v250, v248
    v_mov_b32 v251, v249
    s_nop 0
    v_permlane32_swap_b32 v248, v250
    v_permlane32_swap_b32 v249, v251
    v_max_f32 v196, v248, v250
    v_min_f32 v197, v249, v251
    v_sub_f32 v224, v208, v196
    v_sub_f32 v208, v197, v208
    v_sub_f32 v225, v209, v196
    v_sub_f32 v209, v197, v209
    v_sub_f32 v226, v210, v196
    v_sub_f32 v210, v197, v210
    v_sub_f32 v227, v211, v196
    v_sub_f32 v211, v197, v211
    v_sub_f32 v228, v212, v196
    v_sub_f32 v212, v197, v212
    v_sub_f32 v229, v213, v196
    v_sub_f32 v213, v197, v213
    v_sub_f32 v230, v214, v196
    v_sub_f32 v214, v197, v214
    v_sub_f32 v231, v215, v196
    v_sub_f32 v215, v197, v215
    v_sub_f32 v232, v216, v196
    v_sub_f32 v216, v197, v216
    v_sub_f32 v233, v217, v196
    v_sub_f32 v217, v197, v217
    v_sub_f32 v234, v218, v196
    v_sub_f32 v218, v197, v218
    v_sub_f32 v235, v219, v196
    v_sub_f32 v219, v197, v219
    v_sub_f32 v236, v220, v196
    v_sub_f32 v220, v197, v220
    v_sub_f32 v237, v221, v196
    v_sub_f32 v221, v197, v221
    v_sub_f32 v238, v222, v196
    v_sub_f32 v222, v197, v222
    v_sub_f32 v239, v223, v196
    v_sub_f32 v223, v197, v223
    v_exp_f32 v224, v224
    v_exp_f32 v208, v208
    v_exp_f32 v225, v225
    v_exp_f32 v209, v209
    v_exp_f32 v226, v226
    v_exp_f32 v210, v210
    v_exp_f32 v227, v227
    v_exp_f32 v211, v211
    v_exp_f32 v228, v228
    v_exp_f32 v212, v212
    v_exp_f32 v229, v229
    v_exp_f32 v213, v213
    v_exp_f32 v230, v230
    v_exp_f32 v214, v214
    v_exp_f32 v231, v231
    v_exp_f32 v215, v215
    v_exp_f32 v232, v232
    v_exp_f32 v216, v216
    v_exp_f32 v233, v233
    v_exp_f32 v217, v217
    v_exp_f32 v234, v234
    v_exp_f32 v218, v218
    v_exp_f32 v235, v235
    v_exp_f32 v219, v219
    v_exp_f32 v236, v236
    v_exp_f32 v220, v220
    v_exp_f32 v237, v237
    v_exp_f32 v221, v221
    v_exp_f32 v238, v238
    v_exp_f32 v222, v222
    v_exp_f32 v239, v239
    v_exp_f32 v223, v223
    v_add_f32 v248, v224, v225
    v_add_f32 v250, v208, v209
    v_add_f32 v248, v248, v226
    v_add_f32 v250, v250, v210
    v_add_f32 v248, v248, v227
    v_add_f32 v250, v250, v211
    v_add_f32 v248, v248, v228
    v_add_f32 v250, v250, v212
    v_add_f32 v248, v248, v229
    v_add_f32 v250, v250, v213
    v_add_f32 v248, v248, v230
    v_add_f32 v250, v250, v214
    v_add_f32 v248, v248, v231
    v_add_f32 v250, v250, v215
    v_add_f32 v248, v248, v232
    v_add_f32 v250, v250, v216
    v_add_f32 v248, v248, v233
    v_add_f32 v250, v250, v217
    v_add_f32 v248, v248, v234
    v_add_f32 v250, v250, v218
    v_add_f32 v248, v248, v235
    v_add_f32 v250, v250, v219
    v_fmac_f32 v248, v156, v236
    v_fmac_f32 v250, v156, v220
    v_fmac_f32 v248, v156, v237
    v_fmac_f32 v250, v156, v221
    v_fmac_f32 v248, v156, v238
    v_fmac_f32 v250, v156, v222
    v_fmac_f32 v248, v156, v239
    v_fmac_f32 v250, v156, v223
    s_nop 1
    v_permlane32_swap_b32 v248, v250
    v_add_f32 v248, v248, v250
    s_branch L_fmr_k
L_fms_q:
    v_mfma_f32_32x32x16_bf16 v[208:223], v[240:243], v[200:203], 0
    v_mfma_f32_32x32x16_bf16 v[208:223], v[244:247], v[204:207], v[208:223]
    s_nop 11
    v_bfi_b32 v220, v11, v220, v216
    v_bfi_b32 v221, v11, v221, v216
    v_bfi_b32 v222, v11, v222, v216
    v_bfi_b32 v223, v11, v223, v216
    v_max3_f32 v248, v208, v209, v210
    v_min3_f32 v249, v208, v209, v210
    v_max3_f32 v248, v248, v211, v212
    v_min3_f32 v249, v249, v211, v212
    v_max3_f32 v248, v248, v213, v214
    v_min3_f32 v249, v249, v213, v214
    v_max3_f32 v248, v248, v215, v216
    v_min3_f32 v249, v249, v215, v216
    v_max3_f32 v248, v248, v217, v218
    v_min3_f32 v249, v249, v217, v218
    v_max3_f32 v248, v248, v219, v220
    v_min3_f32 v249, v249, v219, v220
    v_max3_f32 v248, v248, v221, v222
    v_min3_f32 v249, v249, v221, v222
    v_max_f32 v248, v248, v223
    v_min_f32 v249, v249, v223
    v_mov_b32 v250, v248
    v_mov_b32 v251, v249
    s_nop 0
    v_permlane32_swap_b32 v248, v250
    v_permlane32_swap_b32 v249, v251
    v_max_f32 v196, v248, v250
    v_min_f32 v197, v249, v251
    v_sub_f32 v224, v208, v196
    v_sub_f32 v208, v197, v208
    v_sub_f32 v225, v209, v196
    v_sub_f32 v209, v197, v209
    v_sub_f32 v226, v210, v196
    v_sub_f32 v210, v197, v210
    v_sub_f32 v227, v211, v196
    v_sub_f32 v211, v197, v211
    v_sub_f32 v228, v212, v196
    v_sub_f32 v212, v197, v212
    v_sub_f32 v229, v213, v196
    v_sub_f32 v213, v197, v213
    v_sub_f32 v230, v214, v196
    v_sub_f32 v214, v197, v214
    v_sub_f32 v231, v215, v196
    v_sub_f32 v215, v197, v215
    v_sub_f32 v232, v216, v196
    v_sub_f32 v216, v197, v216
    v_sub_f32 v233, v217, v196
    v_sub_f32 v217, v197, v217
    v_sub_f32 v234, v218, v196
    v_sub_f32 v218, v197, v218
    v_sub_f32 v235, v219, v196
    v_sub_f32 v219, v197, v219
    v_sub_f32 v236, v220, v196
    v_sub_f32 v220, v197, v220
    v_sub_f32 v237, v221, v196
    v_sub_f32 v221, v197, v221
    v_sub_f32 v238, v222, v196
    v_sub_f32 v222, v197, v222
    v_sub_f32 v239, v223, v196
    v_sub_f32 v223, v197, v223
    v_exp_f32 v224, v224
    v_exp_f32 v208, v208
    v_exp_f32 v225, v225
    v_exp_f32 v209, v209
    v_exp_f32 v226, v226
    v_exp_f32 v210, v210
    v_exp_f32 v227, v227
    v_exp_f32 v211, v211
    v_exp_f32 v228, v228
    v_exp_f32 v212, v212
    v_exp_f32 v229, v229
    v_exp_f32 v213, v213
    v_exp_f32 v230, v230
    v_exp_f32 v214, v214
    v_exp_f32 v231, v231
    v_exp_f32 v215, v215
    v_exp_f32 v232, v232
    v_exp_f32 v216, v216
    v_exp_f32 v233, v233
    v_exp_f32 v217, v217
    v_exp_f32 v234, v234
    v_exp_f32 v218, v218
    v_exp_f32 v235, v235
    v_exp_f32 v219, v219
    v_exp_f32 v236, v236
    v_exp_f32 v220, v220
    v_exp_f32 v237, v237
    v_exp_f32 v221, v221
    v_exp_f32 v238, v238
    v_exp_f32 v222, v222
    v_exp_f32 v239, v239
    v_exp_f32 v223, v223
    v_add_f32 v248, v224, v225
    v_add_f32 v250, v208, v209
    v_add_f32 v248, v248, v226
    v_add_f32 v250, v250, v210
    v_add_f32 v248, v248, v227
    v_add_f32 v250, v250, v211
    v_add_f32 v248, v248, v228
    v_add_f32 v250, v250, v212
    v_add_f32 v248, v248, v229
    v_add_f32 v250, v250, v213
    v_add_f32 v248, v248, v230
    v_add_f32 v250, v250, v214
    v_add_f32 v248, v248, v231
    v_add_f32 v250, v250, v215
    v_add_f32 v248, v248, v232
    v_add_f32 v250, v250, v216
    v_add_f32 v248, v248, v233
    v_add_f32 v250, v250, v217
    v_add_f32 v248, v248, v234
    v_add_f32 v250, v250, v218
    v_add_f32 v248, v248, v235
    v_add_f32 v250, v250, v219
    v_fmac_f32 v248, v156, v236
    v_fmac_f32 v250, v156, v220
    v_fmac_f32 v248, v156, v237
    v_fmac_f32 v250, v156, v221
    v_fmac_f32 v248, v156, v238
    v_fmac_f32 v250, v156, v222
    v_fmac_f32 v248, v156, v239
    v_fmac_f32 v250, v156, v223
    s_nop 1
    v_permlane32_swap_b32 v248, v250
    v_add_f32 v248, v248, v250
    s_branch L_fmr_q
L_code_end:
.set CODE_BYTES, L_code_end - L_pc - 4
.section .rodata,"a"
.p2align 6
.amdhsa_kernel gated_mix__linear_kernel_hedgehog__sliding_block__prompt_kernel
  .amdhsa_next_free_vgpr 256
  .amdhsa_next_free_sgpr 102
  .amdhsa_accum_offset 256
  .amdhsa_group_segment_fixed_size 0
  .amdhsa_kernarg_size 88
  .amdhsa_user_sgpr_count 2
  .amdhsa_user_sgpr_kernarg_segment_ptr 1
  .amdhsa_system_sgpr_workgroup_id_x 1
.end_amdhsa_kernel
```
